```python
import torch

def _softmax(x, axis=-1):
    return torch.softmax(x, dim=axis)
def _gelu(x):
    return torch.nn.functional.gelu(x, approximate="tanh")
def _silu(x):
    return torch.nn.functional.silu(x)
def _sigmoid(x):
    return torch.sigmoid(x)
def _layernorm(x, axis=-1, eps=1e-5):
    m = x.mean(dim=axis, keepdim=True)
    v = x.var(dim=axis, keepdim=True, unbiased=False)
    return (x - m) / torch.sqrt(v + eps)
def _scatter_add(tgt, idx, src, axis=0):
    return tgt.clone().index_add_(axis, idx, src)
def _segment_sum(src, seg, n):
    out = torch.zeros((n,) + src.shape[1:], dtype=src.dtype)
    return out.index_add_(0, seg, src)
def _pad(x, pw):
    flat = tuple(v for pair in reversed(pw) for v in pair)
    return torch.nn.functional.pad(x, flat)

kernel_name = 'parallel_sum__sliding_block__moe_arch_mod__prompt'

def setup_inputs():

    _w = (lambda a: (lambda t: t.to(torch.bfloat16) if t.is_floating_point() else t)(torch.as_tensor(a)))
    def _A_setup():
        B, S, D = 1, 2048, 512
        return {
            "x": _w((lambda *s: torch.randn(*s, dtype=torch.bfloat16) * 0.05)(B, S, D)),
            "wqkv": _w((lambda *s: torch.randn(*s, dtype=torch.bfloat16) * 0.05)(D, 3 * D)),
            "wo": _w((lambda *s: torch.randn(*s, dtype=torch.bfloat16) * 0.1)(D, D)),
        }
    _A_in = _A_setup()

    def _B_setup():
        B, S, D, F, C = 1, 2048, 512, 1792, 8
        return {
            "x": _w((lambda *s: torch.randn(*s, dtype=torch.bfloat16) * 0.05)(B, S, D)),
            "w_r": _w((lambda *s: torch.randn(*s, dtype=torch.bfloat16) * 0.05)(D)),
            "w_gate": _w((lambda *s: torch.randn(*s, dtype=torch.bfloat16) * 0.05)(D, F)),
            "w_up": _w((lambda *s: torch.randn(*s, dtype=torch.bfloat16) * 0.05)(D, F)),
            "w_down": _w((lambda *s: torch.randn(*s, dtype=torch.bfloat16) * 0.05)(F, D)),
        }
    _B_in = _B_setup()

    return {
        "A_x": _A_in["x"],
        "A_wqkv": _A_in["wqkv"],
        "A_wo": _A_in["wo"],
        "B_x": _B_in["x"],
        "B_w_r": _B_in["w_r"],
        "B_w_gate": _B_in["w_gate"],
        "B_w_up": _B_in["w_up"],
        "B_w_down": _B_in["w_down"],
    }

def reference(A_x, A_wqkv, A_wo, B_x, B_w_r, B_w_gate, B_w_up, B_w_down):
    def _A_ref(x, wqkv, wo):
        B, S, D = x.shape
        H = 32; Dh = D // H; W = 256
        qkv = (lambda x, *d: x.permute(*d))((x @ wqkv).reshape(B, S, 3, H, Dh), 2, 0, 3, 1, 4)
        q, k, v = qkv[0], qkv[1], qkv[2]
        scores = torch.einsum("bhqd,bhkd->bhqk", q, k) * (Dh ** -0.5)
        idx = torch.arange(S)
        mask = (idx[:, None] - idx[None, :] >= 0) & (idx[:, None] - idx[None, :] < W)
        scores = torch.where(mask[None, None], scores, -1e9)
        p = _softmax(scores, axis=-1)
        o = torch.einsum("bhqk,bhkd->bhqd", p, v)
        return (lambda x, *d: x.permute(*d))(o, 0, 2, 1, 3).reshape(B, S, D) @ wo

    def _B_ref(x, w_r, w_gate, w_up, w_down):
        B, S, D = x.shape
        C = 8
        r = x @ w_r
        idx = torch.argsort(-r, axis=-1)[:, :C]
        idx_e = (lambda x, n, axis: torch.repeat_interleave(x, n, dim=axis))(idx.reshape(B, C, 1), D, axis=2)
        x_sel = (lambda x, i, axis: torch.take_along_dim(x, i, dim=axis))(x, idx_e, axis=1)
        g = _silu(x_sel @ w_gate)
        u = x_sel @ w_up
        y = (g * u) @ w_down
        r_sel = _sigmoid((lambda x, i, axis: torch.take_along_dim(x, i, dim=axis))(r, idx, axis=1))
        y = y * r_sel.reshape(B, C, 1)
        b_off = (torch.arange(B) * S).reshape(B, 1)
        flat_idx = (idx + b_off).reshape(B * C)
        zero = (x * 0.0).reshape(B * S, D)
        upd = _scatter_add(zero, flat_idx, y.reshape(B * C, D), axis=0)
        return x + upd.reshape(B, S, D)

    x = A_x
    xn = _layernorm(x, axis=-1)
    return x + _A_ref(xn, A_wqkv, A_wo) + _B_ref(xn, B_w_r, B_w_gate, B_w_up, B_w_down)
```

```asm
; @launch grid=(256,1,1) block=(512,1,1) lds=163840
.amdgcn_target "amdgcn-amd-amdhsa--gfx950"
.text
.globl parallel_sum__sliding_block__moe_arch_mod__prompt_kernel
.p2align 8
.type parallel_sum__sliding_block__moe_arch_mod__prompt_kernel,@function
parallel_sum__sliding_block__moe_arch_mod__prompt_kernel:
    s_cmp_ge_u32 s2, 256
    s_cbranch_scc1 L_exit
    s_nop 0
    s_load_dwordx2 s[4:5], s[0:1], 0
    s_load_dwordx2 s[8:9], s[0:1], 8
    s_load_dwordx2 s[12:13], s[0:1], 80
    s_load_dwordx2 s[36:37], s[0:1], 32
    s_cmp_ge_u32 s2, 32
    s_cbranch_scc1 L1_nopf
    s_getpc_b64 s[54:55]
L_pc:
    s_sub_u32 s54, s54, L_pc-parallel_sum__sliding_block__moe_arch_mod__prompt_kernel
    s_subb_u32 s55, s55, 0
    v_lshlrev_b32_e64 v2, 7, v0
    v_cmp_gt_u32 vcc, L_codeend-parallel_sum__sliding_block__moe_arch_mod__prompt_kernel, v2
    s_nop 1
    s_and_saveexec_b64 s[56:57], vcc
    s_cbranch_execz L1_nopf_r
    global_load_dword v254, v2, s[54:55]
L1_nopf_r:
    s_mov_b64 exec, s[56:57]
L1_nopf:
    v_lshrrev_b32 v1, 6, v0
    v_and_b32 v0, 63, v0
    s_mov_b32 s6, 0x200000
    s_mov_b32 s7, 0x20000
    v_readfirstlane_b32 s38, v1
    s_mov_b32 s10, 0x180000
    s_mov_b32 s11, 0x20000
    s_and_b32 s3, s2, 7
    s_lshr_b32 s42, s2, 3
    s_and_b32 s40, s3, 1
    s_lshl_b32 s40, s40, 2
    s_and_b32 s43, s42, 3
    s_add_u32 s40, s40, s43
    s_lshr_b32 s44, s3, 1
    s_lshr_b32 s43, s42, 2
    s_mul_i32 s39, s44, 7
    s_add_u32 s39, s39, s43
    s_add_u32 s39, s39, 3
    s_cmp_eq_u32 s43, 0
    s_cselect_b32 s39, s44, s39
    s_mov_b32 s14, 0xc00000
    s_mov_b32 s15, 0x20000
    s_cmp_lt_u32 s38, 4
    s_cbranch_scc1 L_chead
L_loader:
    s_sub_u32 s48, s38, 4
    s_lshl_b32 s3, s39, 6
    s_lshl_b32 s43, s48, 11
    v_lshrrev_b32 v1, 3, v0
    s_lshl_b32 s50, s48, 4
    s_add_u32 s3, s3, s50
    v_add_u32 v2, s3, v1
    v_lshlrev_b32 v2, 10, v2
    v_and_b32 v9, 7, v0
    v_lshrrev_b32 v10, 4, v0
    v_xor_b32_e64 v11, v9, v10
    v_lshl_add_u32 v2, v11, 4, v2
    v_add_u32 v3, 0x2000, v2
    v_xor_b32 v3, 64, v3
    v_add_u32 v1, s50, v1
    v_mul_u32_u24 v4, 0xc00, v1
    s_lshl_b32 s3, s40, 7
    v_add_u32 v4, s3, v4
    v_and_b32 v10, 1, v10
    v_lshlrev_b32 v10, 2, v10
    v_xor_b32_e64 v9, v9, v10
    v_lshl_add_u32 v4, v9, 4, v4
    s_lshr_b32 s3, s2, 3
    s_and_b32 s52, s3, 3
    s_lshl_b32 s52, s52, 1
    s_lshr_b32 s3, s3, 2
    s_add_u32 s52, s52, s3
    s_and_b32 s52, s52, 6
    s_lshl_b32 s44, s52, 7
    s_mul_i32 s45, s52, 196608
    s_mov_b32 s46, s43
    s_waitcnt lgkmcnt(0)
    s_add_u32 s53, s52, 1
    s_and_b32 s53, s53, 7
    s_lshl_b32 s53, s53, 7
    s_add_u32 m0, s46, 0
    s_nop 0
    buffer_load_dwordx4 v2, s[4:7], s44 offen lds
    s_add_u32 m0, s46, 1024
    s_nop 0
    buffer_load_dwordx4 v3, s[4:7], s44 offen lds
    s_add_u32 m0, s46, 32768
    s_nop 0
    buffer_load_dwordx4 v2, s[4:7], s53 offen lds
    s_add_u32 m0, s46, 33792
    s_nop 0
    buffer_load_dwordx4 v3, s[4:7], s53 offen lds
    s_add_u32 m0, s46, 8192
    s_add_u32 s47, s45, 0
    buffer_load_dwordx4 v4, s[8:11], s47 offen lds
    s_add_u32 m0, s46, 9216
    s_add_u32 s47, s45, 24576
    buffer_load_dwordx4 v4, s[8:11], s47 offen lds
    s_add_u32 m0, s46, 16384
    s_add_u32 s47, s45, 1024
    buffer_load_dwordx4 v4, s[8:11], s47 offen lds
    s_add_u32 m0, s46, 17408
    s_add_u32 s47, s45, 25600
    buffer_load_dwordx4 v4, s[8:11], s47 offen lds
    s_add_u32 m0, s46, 24576
    s_add_u32 s47, s45, 2048
    buffer_load_dwordx4 v4, s[8:11], s47 offen lds
    s_add_u32 m0, s46, 25600
    s_add_u32 s47, s45, 26624
    buffer_load_dwordx4 v4, s[8:11], s47 offen lds
    s_add_u32 s52, s52, 1
    s_and_b32 s52, s52, 7
    s_lshl_b32 s44, s52, 7
    s_mul_i32 s45, s52, 196608
    s_add_u32 s46, s46, 32768
    s_add_u32 m0, s46, 8192
    s_add_u32 s47, s45, 0
    buffer_load_dwordx4 v4, s[8:11], s47 offen lds
    s_add_u32 m0, s46, 9216
    s_add_u32 s47, s45, 24576
    buffer_load_dwordx4 v4, s[8:11], s47 offen lds
    s_add_u32 m0, s46, 16384
    s_add_u32 s47, s45, 1024
    buffer_load_dwordx4 v4, s[8:11], s47 offen lds
    s_add_u32 m0, s46, 17408
    s_add_u32 s47, s45, 25600
    buffer_load_dwordx4 v4, s[8:11], s47 offen lds
    s_add_u32 m0, s46, 24576
    s_add_u32 s47, s45, 2048
    buffer_load_dwordx4 v4, s[8:11], s47 offen lds
    s_add_u32 m0, s46, 25600
    s_add_u32 s47, s45, 26624
    buffer_load_dwordx4 v4, s[8:11], s47 offen lds
    s_add_u32 s52, s52, 1
    s_and_b32 s52, s52, 7
    s_lshl_b32 s44, s52, 7
    s_mul_i32 s45, s52, 196608
    s_add_u32 s46, s46, 32768
    s_branch L_lsplit
L_chead:
    s_lshl_b32 s3, s39, 6
    s_lshl_b32 s45, s40, 3
    s_add_u32 s45, s45, s3
    s_lshl_b32 s47, s38, 1
    s_add_u32 s45, s45, s47
    v_lshrrev_b32 v176, 5, v0
    v_add_u32 v176, s45, v176
    v_and_b32 v1, 31, v0
    v_lshlrev_b32_e64 v1, 5, v1
    v_lshl_add_u32 v177, v176, 10, v1
    s_waitcnt lgkmcnt(0)
    s_nop 0
    buffer_load_dwordx4 v[180:183], v177, s[4:7], 0 offen
    buffer_load_dwordx4 v[184:187], v177, s[4:7], 0 offen offset:16
    global_load_dwordx4 v[188:191], v1, s[36:37]
    global_load_dwordx4 v[192:195], v1, s[36:37] offset:16
    s_add_u32 s56, s12, 0xa00000
    s_addc_u32 s57, s13, 0
    s_nop 0
    s_load_dword s41, s[56:57], 0
    s_load_dwordx2 s[16:17], s[0:1], 16
    s_mov_b32 s18, 0x80000
    s_mov_b32 s19, 0x20000
    s_load_dwordx2 s[20:21], s[0:1], 64
    s_mov_b32 s22, 0x200000
    s_mov_b32 s23, 0x20000
    s_load_dwordx2 s[24:25], s[0:1], 40
    s_mov_b32 s26, 0x1c0000
    s_mov_b32 s27, 0x20000
    s_load_dwordx2 s[28:29], s[0:1], 48
    s_mov_b32 s30, 0x1c0000
    s_mov_b32 s31, 0x20000
    s_load_dwordx2 s[32:33], s[0:1], 56
    s_mov_b32 s34, 0x1c0000
    s_mov_b32 s35, 0x20000
    s_branch L_crest
L_lsplit:
    s_nop 0
    s_load_dwordx2 s[16:17], s[0:1], 16
    s_mov_b32 s18, 0x80000
    s_mov_b32 s19, 0x20000
    s_load_dwordx2 s[20:21], s[0:1], 64
    s_mov_b32 s22, 0x200000
    s_mov_b32 s23, 0x20000
    s_load_dwordx2 s[24:25], s[0:1], 40
    s_mov_b32 s26, 0x1c0000
    s_mov_b32 s27, 0x20000
    s_load_dwordx2 s[28:29], s[0:1], 48
    s_mov_b32 s30, 0x1c0000
    s_mov_b32 s31, 0x20000
    s_load_dwordx2 s[32:33], s[0:1], 56
    s_mov_b32 s34, 0x1c0000
    s_mov_b32 s35, 0x20000
    s_lshl_b32 s3, s39, 6
    v_add_u32 v12, s3, v0
    v_lshlrev_b32_e64 v12, 3, v12
    v_add_u32 v12, 0xa05000, v12
    s_mov_b32 s51, 6
    s_waitcnt vmcnt(6)
    s_branch L_l1b
    s_nop 0
L_l1:
    s_waitcnt vmcnt(8)
L_l1b:
    s_barrier
    s_add_u32 m0, s46, 0
    s_nop 0
    buffer_load_dwordx4 v2, s[4:7], s44 offen lds
    s_add_u32 m0, s46, 1024
    s_nop 0
    buffer_load_dwordx4 v3, s[4:7], s44 offen lds
    s_add_u32 m0, s46, 8192
    s_add_u32 s47, s45, 0
    buffer_load_dwordx4 v4, s[8:11], s47 offen lds
    s_add_u32 m0, s46, 9216
    s_add_u32 s47, s45, 24576
    buffer_load_dwordx4 v4, s[8:11], s47 offen lds
    s_add_u32 m0, s46, 16384
    s_add_u32 s47, s45, 1024
    buffer_load_dwordx4 v4, s[8:11], s47 offen lds
    s_add_u32 m0, s46, 17408
    s_add_u32 s47, s45, 25600
    buffer_load_dwordx4 v4, s[8:11], s47 offen lds
    s_add_u32 m0, s46, 24576
    s_add_u32 s47, s45, 2048
    buffer_load_dwordx4 v4, s[8:11], s47 offen lds
    s_add_u32 m0, s46, 25600
    s_add_u32 s47, s45, 26624
    buffer_load_dwordx4 v4, s[8:11], s47 offen lds
    s_add_u32 s52, s52, 1
    s_and_b32 s52, s52, 7
    s_lshl_b32 s44, s52, 7
    s_mul_i32 s45, s52, 196608
    s_add_u32 s46, s46, 32768
    s_and_b32 s46, s46, 0x1ffff
    s_sub_u32 s51, s51, 1
    s_cmp_lg_u32 s51, 0
    s_cbranch_scc1 L_l1
    s_lshl_b32 s54, s39, 3
    s_add_u32 s54, s54, s40
    buffer_load_dwordx2 v[42:43], v12, s[12:15], 0 offen sc1
    v_mov_b32 v1, 157248
    ds_read_b32 v1, v1
    s_waitcnt lgkmcnt(0)
    v_readfirstlane_b32 s41, v1
    s_cmp_lt_u32 s54, 28
    s_cbranch_scc1 L_ffnL
    s_waitcnt vmcnt(9)
    s_barrier
    s_waitcnt vmcnt(1)
    s_barrier
    s_waitcnt vmcnt(0)
    s_cmp_lg_u32 s38, 4
    s_cbranch_scc1 L_st_skip
    v_cmp_ne_u32 vcc, s41, v43
    s_nop 1
    s_cbranch_vccz L_st_ok
    s_mov_b32 s58, 20000
L4_poll:
    buffer_load_dwordx2 v[42:43], v12, s[12:15], 0 offen sc1
    s_waitcnt vmcnt(0)
    v_cmp_ne_u32 vcc, s41, v43
    s_nop 1
    s_cbranch_vccz L5_polld
    s_sub_u32 s58, s58, 1
    s_cmp_lg_u32 s58, 0
    s_cbranch_scc1 L4_poll
L5_polld:
L_st_ok:
    v_lshlrev_b32 v44, 16, v42
    v_and_b32 v45, 0xffff0000, v42
    v_rcp_f32 v45, v45
    v_lshlrev_b32 v46, 2, v0
    v_add_u32 v46, 156672, v46
    ds_write_b32 v46, v44
    ds_write_b32 v46, v45 offset:256
L_st_skip:
    s_waitcnt lgkmcnt(0)
    s_barrier
    s_sub_u32 s48, s38, 4
    s_cmp_lg_u32 s38, 7
    s_cbranch_scc1 L6_t3
    s_and_b32 s47, s2, 7
    s_cmp_eq_u32 s47, 7
    s_cbranch_scc1 L6_t3
    s_lshr_b32 s50, s2, 3
    v_lshrrev_b32 v9, 3, v0
    s_lshl_b32 s3, s47, 8
    s_lshl_b32 s50, s50, 3
    s_add_u32 s3, s3, s50
    v_add_u32 v9, s3, v9
    v_lshlrev_b32 v9, 10, v9
    v_and_b32 v8, 7, v0
    v_lshl_add_u32 v9, v8, 7, v9
    buffer_load_dword v199, v9, s[32:35], 0 offen
L6_t3:
    s_add_u32 s88, s39, s48
    s_cmp_lt_u32 s88, 4
    s_cbranch_scc1 L_pre_att
    s_sub_u32 s88, s88, 4
    s_lshl_b32 s89, s88, 3
    s_add_u32 s89, s89, s40
    s_lshl_b32 s89, s89, 7
    s_add_u32 s89, s89, 0xa10000
    v_mov_b32_e64 v2, s89
    s_mov_b64 exec, 1
    s_mov_b32 s58, 20000
L7_poll:
    buffer_load_dword v3, v2, s[12:15], 0 offen sc1
    s_waitcnt vmcnt(0)
    v_cmp_ne_u32 vcc, s41, v3
    s_nop 1
    s_cbranch_vccz L8_polld
    s_sub_u32 s58, s58, 1
    s_cmp_lg_u32 s58, 0
    s_cbranch_scc1 L7_poll
L8_polld:
    s_mov_b64 exec, -1
    s_lshl_b32 s90, s88, 6
    s_lshl_b32 s91, s40, 2
    s_add_u32 s90, s90, s91
    s_lshl_b32 s90, s90, 10
    s_add_u32 s90, s90, 0x400000
    s_lshl_b32 s91, s48, 14
    s_add_u32 s91, s91, 65536
    v_lshlrev_b32 v2, 4, v0
    s_add_u32 m0, s91, 8192
    s_add_u32 s92, s90, 32768
    buffer_load_dwordx4 v2, s[12:15], s92 offen sc1 lds
    s_add_u32 m0, s91, 9216
    s_add_u32 s92, s90, 2129920
    buffer_load_dwordx4 v2, s[12:15], s92 offen sc1 lds
    s_add_u32 m0, s91, 10240
    s_add_u32 s92, s90, 33792
    buffer_load_dwordx4 v2, s[12:15], s92 offen sc1 lds
    s_add_u32 m0, s91, 11264
    s_add_u32 s92, s90, 2130944
    buffer_load_dwordx4 v2, s[12:15], s92 offen sc1 lds
    s_add_u32 m0, s91, 12288
    s_add_u32 s92, s90, 34816
    buffer_load_dwordx4 v2, s[12:15], s92 offen sc1 lds
    s_add_u32 m0, s91, 13312
    s_add_u32 s92, s90, 2131968
    buffer_load_dwordx4 v2, s[12:15], s92 offen sc1 lds
    s_add_u32 m0, s91, 14336
    s_add_u32 s92, s90, 35840
    buffer_load_dwordx4 v2, s[12:15], s92 offen sc1 lds
    s_add_u32 m0, s91, 15360
    s_add_u32 s92, s90, 2132992
    buffer_load_dwordx4 v2, s[12:15], s92 offen sc1 lds
    s_add_u32 m0, s91, 0
    s_add_u32 s92, s90, 0
    buffer_load_dwordx4 v2, s[12:15], s92 offen sc1 lds
    s_add_u32 m0, s91, 1024
    s_add_u32 s92, s90, 2097152
    buffer_load_dwordx4 v2, s[12:15], s92 offen sc1 lds
    s_add_u32 m0, s91, 2048
    s_add_u32 s92, s90, 1024
    buffer_load_dwordx4 v2, s[12:15], s92 offen sc1 lds
    s_add_u32 m0, s91, 3072
    s_add_u32 s92, s90, 2098176
    buffer_load_dwordx4 v2, s[12:15], s92 offen sc1 lds
    s_add_u32 m0, s91, 4096
    s_add_u32 s92, s90, 2048
    buffer_load_dwordx4 v2, s[12:15], s92 offen sc1 lds
    s_add_u32 m0, s91, 5120
    s_add_u32 s92, s90, 2099200
    buffer_load_dwordx4 v2, s[12:15], s92 offen sc1 lds
    s_add_u32 m0, s91, 6144
    s_add_u32 s92, s90, 3072
    buffer_load_dwordx4 v2, s[12:15], s92 offen sc1 lds
    s_add_u32 m0, s91, 7168
    s_add_u32 s92, s90, 2100224
    buffer_load_dwordx4 v2, s[12:15], s92 offen sc1 lds
    s_branch L_pre_att
L_ffnL:
    s_sub_u32 s48, s38, 4
    s_lshl_b32 s3, s48, 10
    v_lshl_add_u32 v10, v0, 4, s3
    v_add_u32 v10, 0xa01000, v10
    s_movk_i32 s3, 0
    buffer_load_dwordx4 v[16:19], v10, s[12:15], s3 offen sc1
    s_movk_i32 s3, 4096
    buffer_load_dwordx4 v[20:23], v10, s[12:15], s3 offen sc1
    s_movk_i32 s3, 8192
    buffer_load_dwordx4 v[24:27], v10, s[12:15], s3 offen sc1
    s_movk_i32 s3, 12288
    buffer_load_dwordx4 v[28:31], v10, s[12:15], s3 offen sc1
    v_lshrrev_b32 v3, 4, v0
    s_lshl_b32 s3, s48, 4
    v_add_u32 v3, s3, v3
    v_mul_u32_u24 v3, 28672, v3
    v_and_b32_e64 v1, 15, v0
    v_lshl_add_u32 v3, v1, 3, v3
    s_lshl_b32 s3, s54, 7
    v_add_u32_e64 v8, s3, v3
    s_waitcnt vmcnt(13)
    s_barrier
    s_waitcnt vmcnt(0)
    s_mov_b32 s58, 20000
L_gchk:
    v_cmp_ne_u32 s[56:57], s41, v17
    v_cmp_ne_u32 vcc, s41, v19
    s_nop 1
    s_or_b64 s[56:57], s[56:57], vcc
    v_cmp_ne_u32 vcc, s41, v21
    s_nop 1
    s_or_b64 s[56:57], s[56:57], vcc
    v_cmp_ne_u32 vcc, s41, v23
    s_nop 1
    s_or_b64 s[56:57], s[56:57], vcc
    v_cmp_ne_u32 vcc, s41, v25
    s_nop 1
    s_or_b64 s[56:57], s[56:57], vcc
    v_cmp_ne_u32 vcc, s41, v27
    s_nop 1
    s_or_b64 s[56:57], s[56:57], vcc
    v_cmp_ne_u32 vcc, s41, v29
    s_nop 1
    s_or_b64 s[56:57], s[56:57], vcc
    v_cmp_ne_u32 vcc, s41, v31
    s_nop 1
    s_or_b64 s[56:57], s[56:57], vcc
    s_cmp_eq_u64 s[56:57], 0
    s_cbranch_scc1 L_gok
    s_sub_u32 s58, s58, 1
    s_cmp_eq_u32 s58, 0
    s_cbranch_scc1 L_gok
    s_movk_i32 s3, 0
    buffer_load_dwordx4 v[16:19], v10, s[12:15], s3 offen sc1
    s_movk_i32 s3, 4096
    buffer_load_dwordx4 v[20:23], v10, s[12:15], s3 offen sc1
    s_movk_i32 s3, 8192
    buffer_load_dwordx4 v[24:27], v10, s[12:15], s3 offen sc1
    s_movk_i32 s3, 12288
    buffer_load_dwordx4 v[28:31], v10, s[12:15], s3 offen sc1
    s_waitcnt vmcnt(0)
    s_branch L_gchk
L_gok:
    s_mov_b32 s59, -1
    v_mov_b32 v40, 0
    v_sub_u32 v32, s59, v16
    v_sub_u32 v33, s59, v18
    v_sub_u32 v34, s59, v20
    v_sub_u32 v35, s59, v22
    v_sub_u32 v36, s59, v24
    v_sub_u32 v37, s59, v26
    v_sub_u32 v38, s59, v28
    v_sub_u32 v39, s59, v30
    v_min3_u32 v32, v32, v33, v34
    v_min3_u32 v35, v35, v36, v37
    v_min3_u32 v32, v32, v38, v39
    v_min_u32 v32, v32, v35
    s_nop 1
    v_min_u32_dpp v32, v32, v32 row_shr:1 row_mask:0xf bank_mask:0xf
    s_nop 1
    v_min_u32_dpp v32, v32, v32 row_shr:2 row_mask:0xf bank_mask:0xf
    s_nop 1
    v_min_u32_dpp v32, v32, v32 row_shr:4 row_mask:0xf bank_mask:0xf
    s_nop 1
    v_min_u32_dpp v32, v32, v32 row_shr:8 row_mask:0xf bank_mask:0xf
    s_nop 1
    v_min_u32_dpp v32, v32, v32 row_bcast:15 row_mask:0xa bank_mask:0xf
    s_nop 1
    v_min_u32_dpp v32, v32, v32 row_bcast:31 row_mask:0xc bank_mask:0xf
    s_nop 0
    v_readlane_b32 s58, v32, 63
    s_nop 1
    s_sub_u32 s59, s59, s58
    v_writelane_b32 v40, s59, 0
    s_sub_u32 s59, s59, 1
    v_sub_u32 v32, s59, v16
    v_sub_u32 v33, s59, v18
    v_sub_u32 v34, s59, v20
    v_sub_u32 v35, s59, v22
    v_sub_u32 v36, s59, v24
    v_sub_u32 v37, s59, v26
    v_sub_u32 v38, s59, v28
    v_sub_u32_e64 v39, s59, v30
    v_min3_u32 v32, v32, v33, v34
    v_min3_u32 v35, v35, v36, v37
    v_min3_u32 v32, v32, v38, v39
    v_min_u32 v32, v32, v35
    s_nop 1
    v_min_u32_dpp v32, v32, v32 row_shr:1 row_mask:0xf bank_mask:0xf
    s_nop 1
    v_min_u32_dpp v32, v32, v32 row_shr:2 row_mask:0xf bank_mask:0xf
    s_nop 1
    v_min_u32_dpp v32, v32, v32 row_shr:4 row_mask:0xf bank_mask:0xf
    s_nop 1
    v_min_u32_dpp v32, v32, v32 row_shr:8 row_mask:0xf bank_mask:0xf
    s_nop 1
    v_min_u32_dpp v32, v32, v32 row_bcast:15 row_mask:0xa bank_mask:0xf
    s_nop 1
    v_min_u32_dpp v32, v32, v32 row_bcast:31 row_mask:0xc bank_mask:0xf
    s_nop 0
    v_readlane_b32 s58, v32, 63
    s_nop 1
    s_sub_u32 s59, s59, s58
    v_writelane_b32 v40, s59, 1
    s_sub_u32 s59, s59, 1
    v_sub_u32 v32, s59, v16
    v_sub_u32 v33, s59, v18
    v_sub_u32 v34, s59, v20
    v_sub_u32 v35, s59, v22
    v_sub_u32 v36, s59, v24
    v_sub_u32 v37, s59, v26
    v_sub_u32 v38, s59, v28
    v_sub_u32_e64 v39, s59, v30
    v_min3_u32 v32, v32, v33, v34
    v_min3_u32 v35, v35, v36, v37
    v_min3_u32 v32, v32, v38, v39
    v_min_u32 v32, v32, v35
    s_nop 1
    v_min_u32_dpp v32, v32, v32 row_shr:1 row_mask:0xf bank_mask:0xf
    s_nop 1
    v_min_u32_dpp v32, v32, v32 row_shr:2 row_mask:0xf bank_mask:0xf
    s_nop 1
    v_min_u32_dpp v32, v32, v32 row_shr:4 row_mask:0xf bank_mask:0xf
    s_nop 1
    v_min_u32_dpp v32, v32, v32 row_shr:8 row_mask:0xf bank_mask:0xf
    s_nop 1
    v_min_u32_dpp v32, v32, v32 row_bcast:15 row_mask:0xa bank_mask:0xf
    s_nop 1
    v_min_u32_dpp v32, v32, v32 row_bcast:31 row_mask:0xc bank_mask:0xf
    s_nop 0
    v_readlane_b32 s58, v32, 63
    s_nop 1
    s_sub_u32 s59, s59, s58
    v_writelane_b32 v40, s59, 2
    s_sub_u32 s59, s59, 1
    s_barrier
    s_mov_b32 s46, 0
    s_nop 0
    buffer_load_dwordx2 v[64:65], v8, s[24:27], s46 offen
    s_mov_b32 s46, 3584
    buffer_load_dwordx2 v[66:67], v8, s[24:27], s46 offen
    s_mov_b32 s46, 7168
    buffer_load_dwordx2 v[68:69], v8, s[24:27], s46 offen
    s_mov_b32 s46, 10752
    buffer_load_dwordx2 v[70:71], v8, s[24:27], s46 offen
    s_mov_b32 s46, 14336
    buffer_load_dwordx2 v[72:73], v8, s[24:27], s46 offen
    s_mov_b32 s46, 17920
    buffer_load_dwordx2 v[74:75], v8, s[24:27], s46 offen
    v_sub_u32 v32, s59, v16
    v_sub_u32 v33, s59, v18
    v_sub_u32 v34, s59, v20
    v_sub_u32 v35, s59, v22
    v_sub_u32 v36, s59, v24
    v_sub_u32 v37, s59, v26
    v_sub_u32 v38, s59, v28
    v_sub_u32 v39, s59, v30
    v_min3_u32 v32, v32, v33, v34
    v_min3_u32 v35, v35, v36, v37
    v_min3_u32 v32, v32, v38, v39
    v_min_u32 v32, v32, v35
    s_nop 1
    v_min_u32_dpp v32, v32, v32 row_shr:1 row_mask:0xf bank_mask:0xf
    s_nop 1
    v_min_u32_dpp v32, v32, v32 row_shr:2 row_mask:0xf bank_mask:0xf
    s_nop 1
    v_min_u32_dpp v32, v32, v32 row_shr:4 row_mask:0xf bank_mask:0xf
    s_nop 1
    v_min_u32_dpp v32, v32, v32 row_shr:8 row_mask:0xf bank_mask:0xf
    s_nop 1
    v_min_u32_dpp v32, v32, v32 row_bcast:15 row_mask:0xa bank_mask:0xf
    s_nop 1
    v_min_u32_dpp v32, v32, v32 row_bcast:31 row_mask:0xc bank_mask:0xf
    s_nop 0
    v_readlane_b32 s58, v32, 63
    s_nop 1
    s_sub_u32 s59, s59, s58
    v_writelane_b32 v40, s59, 3
    s_sub_u32 s59, s59, 1
    s_nop 0
    s_mov_b32 s46, 21504
    buffer_load_dwordx2 v[76:77], v8, s[24:27], s46 offen
    s_mov_b32 s46, 25088
    buffer_load_dwordx2 v[78:79], v8, s[24:27], s46 offen
    s_mov_b32 s46, 114688
    buffer_load_dwordx2 v[80:81], v8, s[24:27], s46 offen
    s_mov_b32 s46, 118272
    buffer_load_dwordx2 v[82:83], v8, s[24:27], s46 offen
    s_mov_b32 s46, 121856
    buffer_load_dwordx2 v[84:85], v8, s[24:27], s46 offen
    s_mov_b32 s46, 125440
    buffer_load_dwordx2 v[86:87], v8, s[24:27], s46 offen
    v_sub_u32 v32, s59, v16
    v_sub_u32 v33, s59, v18
    v_sub_u32 v34, s59, v20
    v_sub_u32 v35, s59, v22
    v_sub_u32 v36, s59, v24
    v_sub_u32 v37, s59, v26
    v_sub_u32 v38, s59, v28
    v_sub_u32 v39, s59, v30
    v_min3_u32 v32, v32, v33, v34
    v_min3_u32 v35, v35, v36, v37
    v_min3_u32 v32, v32, v38, v39
    v_min_u32 v32, v32, v35
    s_nop 1
    v_min_u32_dpp v32, v32, v32 row_shr:1 row_mask:0xf bank_mask:0xf
    s_nop 1
    v_min_u32_dpp v32, v32, v32 row_shr:2 row_mask:0xf bank_mask:0xf
    s_nop 1
    v_min_u32_dpp v32, v32, v32 row_shr:4 row_mask:0xf bank_mask:0xf
    s_nop 1
    v_min_u32_dpp v32, v32, v32 row_shr:8 row_mask:0xf bank_mask:0xf
    s_nop 1
    v_min_u32_dpp v32, v32, v32 row_bcast:15 row_mask:0xa bank_mask:0xf
    s_nop 1
    v_min_u32_dpp v32, v32, v32 row_bcast:31 row_mask:0xc bank_mask:0xf
    s_nop 0
    v_readlane_b32 s58, v32, 63
    s_nop 1
    s_sub_u32 s59, s59, s58
    v_writelane_b32 v40, s59, 4
    s_sub_u32 s59, s59, 1
    s_nop 0
    s_mov_b32 s46, 129024
    buffer_load_dwordx2 v[88:89], v8, s[24:27], s46 offen
    s_mov_b32 s46, 132608
    buffer_load_dwordx2 v[90:91], v8, s[24:27], s46 offen
    s_mov_b32 s46, 136192
    buffer_load_dwordx2 v[92:93], v8, s[24:27], s46 offen
    s_mov_b32 s46, 139776
    buffer_load_dwordx2 v[94:95], v8, s[24:27], s46 offen
    s_mov_b32 s46, 229376
    buffer_load_dwordx2 v[96:97], v8, s[24:27], s46 offen
    s_mov_b32 s46, 232960
    buffer_load_dwordx2 v[98:99], v8, s[24:27], s46 offen
    v_sub_u32 v32, s59, v16
    v_sub_u32 v33, s59, v18
    v_sub_u32 v34, s59, v20
    v_sub_u32 v35, s59, v22
    v_sub_u32 v36, s59, v24
    v_sub_u32 v37, s59, v26
    v_sub_u32 v38, s59, v28
    v_sub_u32 v39, s59, v30
    v_min3_u32 v32, v32, v33, v34
    v_min3_u32 v35, v35, v36, v37
    v_min3_u32 v32, v32, v38, v39
    v_min_u32 v32, v32, v35
    s_nop 1
    v_min_u32_dpp v32, v32, v32 row_shr:1 row_mask:0xf bank_mask:0xf
    s_nop 1
    v_min_u32_dpp v32, v32, v32 row_shr:2 row_mask:0xf bank_mask:0xf
    s_nop 1
    v_min_u32_dpp v32, v32, v32 row_shr:4 row_mask:0xf bank_mask:0xf
    s_nop 1
    v_min_u32_dpp v32, v32, v32 row_shr:8 row_mask:0xf bank_mask:0xf
    s_nop 1
    v_min_u32_dpp v32, v32, v32 row_bcast:15 row_mask:0xa bank_mask:0xf
    s_nop 1
    v_min_u32_dpp v32, v32, v32 row_bcast:31 row_mask:0xc bank_mask:0xf
    s_nop 0
    v_readlane_b32 s58, v32, 63
    s_nop 1
    s_sub_u32 s59, s59, s58
    v_writelane_b32 v40, s59, 5
    s_sub_u32 s59, s59, 1
    s_nop 0
    s_mov_b32 s46, 236544
    buffer_load_dwordx2 v[100:101], v8, s[24:27], s46 offen
    s_mov_b32 s46, 240128
    buffer_load_dwordx2 v[102:103], v8, s[24:27], s46 offen
    s_mov_b32 s46, 243712
    buffer_load_dwordx2 v[104:105], v8, s[24:27], s46 offen
    s_mov_b32 s46, 247296
    buffer_load_dwordx2 v[106:107], v8, s[24:27], s46 offen
    s_mov_b32 s46, 250880
    buffer_load_dwordx2 v[108:109], v8, s[24:27], s46 offen
    s_mov_b32 s46, 254464
    buffer_load_dwordx2 v[110:111], v8, s[24:27], s46 offen
    v_sub_u32 v32, s59, v16
    v_sub_u32 v33, s59, v18
    v_sub_u32 v34, s59, v20
    v_sub_u32 v35, s59, v22
    v_sub_u32 v36, s59, v24
    v_sub_u32 v37, s59, v26
    v_sub_u32 v38, s59, v28
    v_sub_u32 v39, s59, v30
    v_min3_u32 v32, v32, v33, v34
    v_min3_u32 v35, v35, v36, v37
    v_min3_u32 v32, v32, v38, v39
    v_min_u32 v32, v32, v35
    s_nop 1
    v_min_u32_dpp v32, v32, v32 row_shr:1 row_mask:0xf bank_mask:0xf
    s_nop 1
    v_min_u32_dpp v32, v32, v32 row_shr:2 row_mask:0xf bank_mask:0xf
    s_nop 1
    v_min_u32_dpp v32, v32, v32 row_shr:4 row_mask:0xf bank_mask:0xf
    s_nop 1
    v_min_u32_dpp v32, v32, v32 row_shr:8 row_mask:0xf bank_mask:0xf
    s_nop 1
    v_min_u32_dpp v32, v32, v32 row_bcast:15 row_mask:0xa bank_mask:0xf
    s_nop 1
    v_min_u32_dpp v32, v32, v32 row_bcast:31 row_mask:0xc bank_mask:0xf
    s_nop 0
    v_readlane_b32 s58, v32, 63
    s_nop 1
    s_sub_u32 s59, s59, s58
    v_writelane_b32 v40, s59, 6
    s_sub_u32 s59, s59, 1
    s_nop 0
    s_mov_b32 s46, 344064
    buffer_load_dwordx2 v[112:113], v8, s[24:27], s46 offen
    s_mov_b32 s46, 347648
    buffer_load_dwordx2 v[114:115], v8, s[24:27], s46 offen
    s_mov_b32 s46, 351232
    buffer_load_dwordx2 v[116:117], v8, s[24:27], s46 offen
    s_mov_b32 s46, 354816
    buffer_load_dwordx2 v[118:119], v8, s[24:27], s46 offen
    s_mov_b32 s46, 358400
    buffer_load_dwordx2 v[120:121], v8, s[24:27], s46 offen
    s_mov_b32 s46, 361984
    buffer_load_dwordx2 v[122:123], v8, s[24:27], s46 offen
    v_sub_u32 v32, s59, v16
    v_sub_u32 v33, s59, v18
    v_sub_u32 v34, s59, v20
    v_sub_u32 v35, s59, v22
    v_sub_u32 v36, s59, v24
    v_sub_u32 v37, s59, v26
    v_sub_u32 v38, s59, v28
    v_sub_u32 v39, s59, v30
    v_min3_u32 v32, v32, v33, v34
    v_min3_u32 v35, v35, v36, v37
    v_min3_u32 v32, v32, v38, v39
    v_min_u32 v32, v32, v35
    s_nop 1
    v_min_u32_dpp v32, v32, v32 row_shr:1 row_mask:0xf bank_mask:0xf
    s_nop 1
    v_min_u32_dpp v32, v32, v32 row_shr:2 row_mask:0xf bank_mask:0xf
    s_nop 1
    v_min_u32_dpp v32, v32, v32 row_shr:4 row_mask:0xf bank_mask:0xf
    s_nop 1
    v_min_u32_dpp v32, v32, v32 row_shr:8 row_mask:0xf bank_mask:0xf
    s_nop 1
    v_min_u32_dpp v32, v32, v32 row_bcast:15 row_mask:0xa bank_mask:0xf
    s_nop 1
    v_min_u32_dpp v32, v32, v32 row_bcast:31 row_mask:0xc bank_mask:0xf
    s_nop 0
    v_readlane_b32 s58, v32, 63
    s_nop 1
    s_sub_u32 s59, s59, s58
    v_writelane_b32 v40, s59, 7
    s_sub_u32 s59, s59, 1
    s_lshl_b32 s58, s48, 5
    s_add_u32 s58, s58, 157696
    v_lshl_add_u32 v32, v0, 2, s58
    s_mov_b64 exec, 0xff
    ds_write_b32 v32, v40
    s_mov_b64 exec, -1
    s_cmp_lg_u32 s38, 4
    s_cbranch_scc1 L_stf_skip
    v_cmp_ne_u32 vcc, s41, v43
    s_nop 1
    s_cbranch_vccz L_stf_ok
    s_mov_b32 s58, 20000
L9_poll:
    buffer_load_dwordx2 v[42:43], v12, s[12:15], 0 offen sc1
    s_waitcnt vmcnt(0)
    v_cmp_ne_u32 vcc, s41, v43
    s_nop 1
    s_cbranch_vccz L10_polld
    s_sub_u32 s58, s58, 1
    s_cmp_lg_u32 s58, 0
    s_cbranch_scc1 L9_poll
L10_polld:
L_stf_ok:
    v_lshlrev_b32 v44, 16, v42
    v_and_b32 v45, 0xffff0000, v42
    v_rcp_f32 v45, v45
    v_lshlrev_b32 v46, 2, v0
    v_add_u32 v46, 156672, v46
    ds_write_b32 v46, v44
    ds_write_b32 v46, v45 offset:256
L_stf_skip:
    s_waitcnt lgkmcnt(0)
    s_barrier
    v_and_b32 v32, 31, v0
    v_lshlrev_b32 v32, 2, v32
    v_add_u32 v32, 157696, v32
    ds_read_b32 v36, v32
    s_mov_b32 s59, -1
    s_nop 0
    s_mov_b32 s46, 365568
    buffer_load_dwordx2 v[124:125], v8, s[24:27], s46 offen
    s_mov_b32 s46, 369152
    buffer_load_dwordx2 v[126:127], v8, s[24:27], s46 offen
    s_mov_b32 s46, 0
    buffer_load_dwordx2 v[128:129], v8, s[28:31], s46 offen
    s_waitcnt lgkmcnt(0)
    v_sub_u32 v32, s59, v36
    s_nop 1
    v_min_u32_dpp v32, v32, v32 row_shr:1 row_mask:0xf bank_mask:0xf
    s_nop 1
    v_min_u32_dpp v32, v32, v32 row_shr:2 row_mask:0xf bank_mask:0xf
    s_nop 1
    v_min_u32_dpp v32, v32, v32 row_shr:4 row_mask:0xf bank_mask:0xf
    s_nop 1
    v_min_u32_dpp v32, v32, v32 row_shr:8 row_mask:0xf bank_mask:0xf
    s_nop 1
    v_min_u32_dpp v32, v32, v32 row_bcast:15 row_mask:0xa bank_mask:0xf
    s_nop 1
    v_min_u32_dpp v32, v32, v32 row_bcast:31 row_mask:0xc bank_mask:0xf
    s_nop 0
    v_readlane_b32 s58, v32, 63
    s_nop 1
    s_sub_u32 s60, s59, s58
    s_sub_u32 s59, s60, 1
    s_nop 0
    s_mov_b32 s46, 3584
    buffer_load_dwordx2 v[130:131], v8, s[28:31], s46 offen
    s_mov_b32 s46, 7168
    buffer_load_dwordx2 v[132:133], v8, s[28:31], s46 offen
    s_mov_b32 s46, 10752
    buffer_load_dwordx2 v[134:135], v8, s[28:31], s46 offen
    v_sub_u32 v32, s59, v36
    s_nop 1
    v_min_u32_dpp v32, v32, v32 row_shr:1 row_mask:0xf bank_mask:0xf
    s_nop 1
    v_min_u32_dpp v32, v32, v32 row_shr:2 row_mask:0xf bank_mask:0xf
    s_nop 1
    v_min_u32_dpp v32, v32, v32 row_shr:4 row_mask:0xf bank_mask:0xf
    s_nop 1
    v_min_u32_dpp v32, v32, v32 row_shr:8 row_mask:0xf bank_mask:0xf
    s_nop 1
    v_min_u32_dpp v32, v32, v32 row_bcast:15 row_mask:0xa bank_mask:0xf
    s_nop 1
    v_min_u32_dpp v32, v32, v32 row_bcast:31 row_mask:0xc bank_mask:0xf
    s_nop 0
    v_readlane_b32 s58, v32, 63
    s_nop 1
    s_sub_u32 s61, s59, s58
    s_sub_u32 s59, s61, 1
    s_nop 0
    s_mov_b32 s46, 14336
    buffer_load_dwordx2 v[136:137], v8, s[28:31], s46 offen
    s_mov_b32 s46, 17920
    buffer_load_dwordx2 v[138:139], v8, s[28:31], s46 offen
    s_mov_b32 s46, 21504
    buffer_load_dwordx2 v[140:141], v8, s[28:31], s46 offen
    v_sub_u32 v32, s59, v36
    s_nop 1
    v_min_u32_dpp v32, v32, v32 row_shr:1 row_mask:0xf bank_mask:0xf
    s_nop 1
    v_min_u32_dpp v32, v32, v32 row_shr:2 row_mask:0xf bank_mask:0xf
    s_nop 1
    v_min_u32_dpp v32, v32, v32 row_shr:4 row_mask:0xf bank_mask:0xf
    s_nop 1
    v_min_u32_dpp v32, v32, v32 row_shr:8 row_mask:0xf bank_mask:0xf
    s_nop 1
    v_min_u32_dpp v32, v32, v32 row_bcast:15 row_mask:0xa bank_mask:0xf
    s_nop 1
    v_min_u32_dpp v32, v32, v32 row_bcast:31 row_mask:0xc bank_mask:0xf
    s_nop 0
    v_readlane_b32 s58, v32, 63
    s_nop 1
    s_sub_u32 s62, s59, s58
    s_sub_u32 s59, s62, 1
    s_nop 0
    s_mov_b32 s46, 25088
    buffer_load_dwordx2 v[142:143], v8, s[28:31], s46 offen
    s_mov_b32 s46, 114688
    buffer_load_dwordx2 v[144:145], v8, s[28:31], s46 offen
    s_mov_b32 s46, 118272
    buffer_load_dwordx2 v[146:147], v8, s[28:31], s46 offen
    v_sub_u32 v32, s59, v36
    s_nop 1
    v_min_u32_dpp v32, v32, v32 row_shr:1 row_mask:0xf bank_mask:0xf
    s_nop 1
    v_min_u32_dpp v32, v32, v32 row_shr:2 row_mask:0xf bank_mask:0xf
    s_nop 1
    v_min_u32_dpp v32, v32, v32 row_shr:4 row_mask:0xf bank_mask:0xf
    s_nop 1
    v_min_u32_dpp v32, v32, v32 row_shr:8 row_mask:0xf bank_mask:0xf
    s_nop 1
    v_min_u32_dpp v32, v32, v32 row_bcast:15 row_mask:0xa bank_mask:0xf
    s_nop 1
    v_min_u32_dpp v32, v32, v32 row_bcast:31 row_mask:0xc bank_mask:0xf
    s_nop 0
    v_readlane_b32 s58, v32, 63
    s_nop 1
    s_sub_u32 s63, s59, s58
    s_sub_u32 s59, s63, 1
    s_nop 0
    s_mov_b32 s46, 121856
    buffer_load_dwordx2 v[148:149], v8, s[28:31], s46 offen
    s_mov_b32 s46, 125440
    buffer_load_dwordx2 v[150:151], v8, s[28:31], s46 offen
    s_mov_b32 s46, 129024
    buffer_load_dwordx2 v[152:153], v8, s[28:31], s46 offen
    v_sub_u32 v32, s59, v36
    s_nop 1
    v_min_u32_dpp v32, v32, v32 row_shr:1 row_mask:0xf bank_mask:0xf
    s_nop 1
    v_min_u32_dpp v32, v32, v32 row_shr:2 row_mask:0xf bank_mask:0xf
    s_nop 1
    v_min_u32_dpp v32, v32, v32 row_shr:4 row_mask:0xf bank_mask:0xf
    s_nop 1
    v_min_u32_dpp v32, v32, v32 row_shr:8 row_mask:0xf bank_mask:0xf
    s_nop 1
    v_min_u32_dpp v32, v32, v32 row_bcast:15 row_mask:0xa bank_mask:0xf
    s_nop 1
    v_min_u32_dpp v32, v32, v32 row_bcast:31 row_mask:0xc bank_mask:0xf
    s_nop 0
    v_readlane_b32 s58, v32, 63
    s_nop 1
    s_sub_u32 s64, s59, s58
    s_sub_u32 s59, s64, 1
    s_nop 0
    s_mov_b32 s46, 132608
    buffer_load_dwordx2 v[154:155], v8, s[28:31], s46 offen
    s_mov_b32 s46, 136192
    buffer_load_dwordx2 v[156:157], v8, s[28:31], s46 offen
    s_mov_b32 s46, 139776
    buffer_load_dwordx2 v[158:159], v8, s[28:31], s46 offen
    v_sub_u32 v32, s59, v36
    s_nop 1
    v_min_u32_dpp v32, v32, v32 row_shr:1 row_mask:0xf bank_mask:0xf
    s_nop 1
    v_min_u32_dpp v32, v32, v32 row_shr:2 row_mask:0xf bank_mask:0xf
    s_nop 1
    v_min_u32_dpp v32, v32, v32 row_shr:4 row_mask:0xf bank_mask:0xf
    s_nop 1
    v_min_u32_dpp v32, v32, v32 row_shr:8 row_mask:0xf bank_mask:0xf
    s_nop 1
    v_min_u32_dpp v32, v32, v32 row_bcast:15 row_mask:0xa bank_mask:0xf
    s_nop 1
    v_min_u32_dpp v32, v32, v32 row_bcast:31 row_mask:0xc bank_mask:0xf
    s_nop 0
    v_readlane_b32 s58, v32, 63
    s_nop 1
    s_sub_u32 s65, s59, s58
    s_sub_u32 s59, s65, 1
    s_nop 0
    s_mov_b32 s46, 229376
    buffer_load_dwordx2 v[160:161], v8, s[28:31], s46 offen
    s_mov_b32 s46, 232960
    buffer_load_dwordx2 v[162:163], v8, s[28:31], s46 offen
    s_mov_b32 s46, 236544
    buffer_load_dwordx2 v[164:165], v8, s[28:31], s46 offen
    v_sub_u32 v32, s59, v36
    s_nop 1
    v_min_u32_dpp v32, v32, v32 row_shr:1 row_mask:0xf bank_mask:0xf
    s_nop 1
    v_min_u32_dpp v32, v32, v32 row_shr:2 row_mask:0xf bank_mask:0xf
    s_nop 1
    v_min_u32_dpp v32, v32, v32 row_shr:4 row_mask:0xf bank_mask:0xf
    s_nop 1
    v_min_u32_dpp v32, v32, v32 row_shr:8 row_mask:0xf bank_mask:0xf
    s_nop 1
    v_min_u32_dpp v32, v32, v32 row_bcast:15 row_mask:0xa bank_mask:0xf
    s_nop 1
    v_min_u32_dpp v32, v32, v32 row_bcast:31 row_mask:0xc bank_mask:0xf
    s_nop 0
    v_readlane_b32 s58, v32, 63
    s_nop 1
    s_sub_u32 s66, s59, s58
    s_sub_u32 s59, s66, 1
    s_nop 0
    s_mov_b32 s46, 240128
    buffer_load_dwordx2 v[166:167], v8, s[28:31], s46 offen
    s_mov_b32 s46, 243712
    buffer_load_dwordx2 v[168:169], v8, s[28:31], s46 offen
    s_mov_b32 s46, 247296
    buffer_load_dwordx2 v[170:171], v8, s[28:31], s46 offen
    v_sub_u32 v32, s59, v36
    s_nop 1
    v_min_u32_dpp v32, v32, v32 row_shr:1 row_mask:0xf bank_mask:0xf
    s_nop 1
    v_min_u32_dpp v32, v32, v32 row_shr:2 row_mask:0xf bank_mask:0xf
    s_nop 1
    v_min_u32_dpp v32, v32, v32 row_shr:4 row_mask:0xf bank_mask:0xf
    s_nop 1
    v_min_u32_dpp v32, v32, v32 row_shr:8 row_mask:0xf bank_mask:0xf
    s_nop 1
    v_min_u32_dpp v32, v32, v32 row_bcast:15 row_mask:0xa bank_mask:0xf
    s_nop 1
    v_min_u32_dpp v32, v32, v32 row_bcast:31 row_mask:0xc bank_mask:0xf
    s_nop 0
    v_readlane_b32 s58, v32, 63
    s_nop 1
    s_sub_u32 s67, s59, s58
    s_sub_u32 s59, s67, 1
    v_and_b32 v1, 7, v0
    v_mov_b32 v2, s60
    v_mov_b32 v3, s61
    v_cmp_eq_u32 s[56:57], 1, v1
    s_nop 1
    v_cndmask_b32 v2, v2, v3, s[56:57]
    v_mov_b32 v3, s62
    v_cmp_eq_u32 s[56:57], 2, v1
    s_nop 1
    v_cndmask_b32 v2, v2, v3, s[56:57]
    v_mov_b32 v3, s63
    v_cmp_eq_u32 s[56:57], 3, v1
    s_nop 1
    v_cndmask_b32 v2, v2, v3, s[56:57]
    v_mov_b32 v3, s64
    v_cmp_eq_u32 s[56:57], 4, v1
    s_nop 1
    v_cndmask_b32 v2, v2, v3, s[56:57]
    v_mov_b32 v3, s65
    v_cmp_eq_u32 s[56:57], 5, v1
    s_nop 1
    v_cndmask_b32 v2, v2, v3, s[56:57]
    v_mov_b32 v3, s66
    v_cmp_eq_u32 s[56:57], 6, v1
    s_nop 1
    v_cndmask_b32 v2, v2, v3, s[56:57]
    v_mov_b32 v3, s67
    v_cmp_eq_u32 s[56:57], 7, v1
    s_nop 1
    v_cndmask_b32 v2, v2, v3, s[56:57]
    v_mov_b32 v14, v2
    v_and_b32 v2, 0xffff, v2
    v_sub_u32 v2, 0x7ff, v2
    v_mov_b32_e64 v15, v2
    s_cmp_lg_u32 s54, 0
    s_cbranch_scc1 L_nosel
    s_cmp_lg_u32 s38, 4
    s_cbranch_scc1 L_nosel
    v_and_b32 v60, 0xffff0000, v14
    v_ashrrev_i32 v61, 31, v60
    v_not_b32 v61, v61
    v_or_b32 v61, 0x80000000, v61
    v_xor_b32_e64 v60, v60, v61
    v_and_b32 v60, 0xffff0000, v60
    v_mul_f32 v60, 0xbfb8aa3b, v60
    v_exp_f32 v60, v60
    s_nop 0
    v_add_f32 v60, 1.0, v60
    v_rcp_f32_e64 v60, v60
    s_nop 0
    v_cvt_pk_bf16_f32 v60, v60, 0
    v_lshl_or_b32 v60, v60, 16, v15
    v_mov_b32 v61, s41
    v_lshlrev_b32 v62, 3, v0
    v_add_u32 v62, 0xa09000, v62
    s_mov_b64 exec, 0xff
    buffer_store_dwordx2 v[60:61], v62, s[12:15], 0 offen sc1
    s_mov_b64 exec, 1
    v_mov_b32 v62, 0xa00000
    buffer_store_dword v61, v62, s[12:15], 0 offen sc1
    s_mov_b64 exec, -1
L_nosel:
    v_mov_b32 v2, v15
    v_lshlrev_b32 v11, 3, v15
    v_add_u32 v11, 0xa05000, v11
    v_lshlrev_b32 v2, 10, v2
    v_lshrrev_b32 v3, 4, v0
    v_lshl_add_u32 v2, v3, 4, v2
    v_bfe_u32 v3, v0, 3, 1
    v_lshl_add_u32 v2, v3, 6, v2
    s_lshl_b32 s3, s48, 8
    s_waitcnt vmcnt(48)
    buffer_load_dwordx2 v[56:57], v11, s[12:15], 0 offen sc1
    buffer_load_dwordx4 v[48:51], v2, s[4:7], s3 offen
    buffer_load_dwordx4 v[52:55], v2, s[4:7], s3 offen offset:128
    s_mov_b32 s46, 250880
    buffer_load_dwordx2 v[172:173], v8, s[28:31], s46 offen
    s_mov_b32 s46, 254464
    buffer_load_dwordx2 v[174:175], v8, s[28:31], s46 offen
    s_mov_b32 s46, 344064
    buffer_load_dwordx2 v[176:177], v8, s[28:31], s46 offen
    s_mov_b32 s46, 347648
    buffer_load_dwordx2 v[178:179], v8, s[28:31], s46 offen
    s_mov_b32 s46, 351232
    buffer_load_dwordx2 v[180:181], v8, s[28:31], s46 offen
    s_mov_b32 s46, 354816
    buffer_load_dwordx2 v[182:183], v8, s[28:31], s46 offen
    s_mov_b32 s46, 358400
    buffer_load_dwordx2 v[184:185], v8, s[28:31], s46 offen
    s_mov_b32 s46, 361984
    buffer_load_dwordx2 v[186:187], v8, s[28:31], s46 offen
    s_mov_b32 s46, 365568
    buffer_load_dwordx2 v[188:189], v8, s[28:31], s46 offen
    s_mov_b32 s46, 369152
    buffer_load_dwordx2 v[190:191], v8, s[28:31], s46 offen
    s_mov_b32 s60, 0x05040100
    s_mov_b32 s61, 0x07060302
    s_waitcnt vmcnt(10)
    v_cmp_ne_u32 vcc, s41, v57
    s_nop 1
    s_cbranch_vccz L_sgok
    s_mov_b32 s58, 20000
L11_poll:
    buffer_load_dwordx2 v[56:57], v11, s[12:15], 0 offen sc1
    s_waitcnt vmcnt(0)
    v_cmp_ne_u32 vcc, s41, v57
    s_nop 1
    s_cbranch_vccz L12_polld
    s_sub_u32 s58, s58, 1
    s_cmp_lg_u32 s58, 0
    s_cbranch_scc1 L11_poll
L12_polld:
L_sgok:
    s_cmp_ge_u32 s39, 2
    s_cbranch_scc1 L13_lp
    s_setprio 1
L13_lp:
    v_lshlrev_b32_e64 v58, 16, v56
    v_and_b32 v59, 0xffff0000, v56
    v_rcp_f32 v59, v59
    v_lshlrev_b32 v60, 16, v48
    v_and_b32 v61, 0xffff0000, v48
    v_sub_f32 v60, v60, v58
    v_sub_f32 v61, v61, v58
    v_cvt_pk_bf16_f32 v60, v60, v61
    v_and_b32 v61, 0xffff0000, v60
    v_lshlrev_b32 v60, 16, v60
    v_mul_f32 v60, v59, v60
    v_mul_f32_e64 v61, v59, v61
    v_cvt_pk_bf16_f32 v48, v60, v61
    v_lshlrev_b32_e64 v60, 16, v49
    v_and_b32 v61, 0xffff0000, v49
    v_sub_f32 v60, v60, v58
    v_sub_f32 v61, v61, v58
    v_cvt_pk_bf16_f32 v60, v60, v61
    v_and_b32 v61, 0xffff0000, v60
    v_lshlrev_b32 v60, 16, v60
    v_mul_f32 v60, v59, v60
    v_mul_f32_e64 v61, v59, v61
    v_cvt_pk_bf16_f32 v49, v60, v61
    v_lshlrev_b32_e64 v60, 16, v50
    v_and_b32 v61, 0xffff0000, v50
    v_sub_f32 v60, v60, v58
    v_sub_f32 v61, v61, v58
    v_cvt_pk_bf16_f32 v60, v60, v61
    v_and_b32 v61, 0xffff0000, v60
    v_lshlrev_b32 v60, 16, v60
    v_mul_f32 v60, v59, v60
    v_mul_f32_e64 v61, v59, v61
    v_cvt_pk_bf16_f32 v50, v60, v61
    v_lshlrev_b32_e64 v60, 16, v51
    v_and_b32 v61, 0xffff0000, v51
    v_sub_f32 v60, v60, v58
    v_sub_f32 v61, v61, v58
    v_cvt_pk_bf16_f32 v60, v60, v61
    v_and_b32 v61, 0xffff0000, v60
    v_lshlrev_b32 v60, 16, v60
    v_mul_f32 v60, v59, v60
    v_mul_f32_e64 v61, v59, v61
    v_cvt_pk_bf16_f32 v51, v60, v61
    v_lshlrev_b32_e64 v60, 16, v52
    v_and_b32 v61, 0xffff0000, v52
    v_sub_f32 v60, v60, v58
    v_sub_f32 v61, v61, v58
    v_cvt_pk_bf16_f32 v60, v60, v61
    v_and_b32 v61, 0xffff0000, v60
    v_lshlrev_b32 v60, 16, v60
    v_mul_f32 v60, v59, v60
    v_mul_f32_e64 v61, v59, v61
    v_cvt_pk_bf16_f32 v52, v60, v61
    v_lshlrev_b32_e64 v60, 16, v53
    v_and_b32 v61, 0xffff0000, v53
    v_sub_f32 v60, v60, v58
    v_sub_f32 v61, v61, v58
    v_cvt_pk_bf16_f32 v60, v60, v61
    v_and_b32 v61, 0xffff0000, v60
    v_lshlrev_b32 v60, 16, v60
    v_mul_f32 v60, v59, v60
    v_mul_f32_e64 v61, v59, v61
    v_cvt_pk_bf16_f32 v53, v60, v61
    v_lshlrev_b32_e64 v60, 16, v54
    v_and_b32 v61, 0xffff0000, v54
    v_sub_f32 v60, v60, v58
    v_sub_f32 v61, v61, v58
    v_cvt_pk_bf16_f32 v60, v60, v61
    v_and_b32 v61, 0xffff0000, v60
    v_lshlrev_b32 v60, 16, v60
    v_mul_f32 v60, v59, v60
    v_mul_f32_e64 v61, v59, v61
    v_cvt_pk_bf16_f32 v54, v60, v61
    v_lshlrev_b32_e64 v60, 16, v55
    v_and_b32 v61, 0xffff0000, v55
    v_sub_f32 v60, v60, v58
    v_sub_f32 v61, v61, v58
    v_cvt_pk_bf16_f32 v60, v60, v61
    v_and_b32 v61, 0xffff0000, v60
    v_lshlrev_b32 v60, 16, v60
    v_mul_f32 v60, v59, v60
    v_mul_f32_e64 v61, v59, v61
    v_cvt_pk_bf16_f32 v55, v60, v61
    v_perm_b32 v192, v66, v64, s60
    v_perm_b32 v196, v66, v64, s61
    v_perm_b32 v193, v70, v68, s60
    v_perm_b32 v197, v70, v68, s61
    v_perm_b32 v194, v74, v72, s60
    v_perm_b32 v198, v74, v72, s61
    v_perm_b32 v195, v78, v76, s60
    v_perm_b32 v199, v78, v76, s61
    v_perm_b32 v200, v67, v65, s60
    v_perm_b32 v204, v67, v65, s61
    v_perm_b32 v201, v71, v69, s60
    v_perm_b32 v205, v71, v69, s61
    v_perm_b32 v202, v75, v73, s60
    v_perm_b32 v206, v75, v73, s61
    v_perm_b32 v203, v79, v77, s60
    v_perm_b32 v207, v79, v77, s61
    v_mfma_f32_16x16x32_bf16 v[16:19], v[192:195], v[48:51], 0
    v_mfma_f32_16x16x32_bf16 v[24:27], v[196:199], v[48:51], 0
    v_mfma_f32_16x16x32_bf16 v[32:35], v[200:203], v[48:51], 0
    v_mfma_f32_16x16x32_bf16 v[40:43], v[204:207], v[48:51], 0
    v_perm_b32 v208, v82, v80, s60
    v_perm_b32 v212, v82, v80, s61
    v_perm_b32 v209, v86, v84, s60
    v_perm_b32 v213, v86, v84, s61
    v_perm_b32 v210, v90, v88, s60
    v_perm_b32 v214, v90, v88, s61
    v_perm_b32 v211, v94, v92, s60
    v_perm_b32 v215, v94, v92, s61
    v_perm_b32 v216, v83, v81, s60
    v_perm_b32 v220, v83, v81, s61
    v_perm_b32 v217, v87, v85, s60
    v_perm_b32 v221, v87, v85, s61
    v_perm_b32 v218, v91, v89, s60
    v_perm_b32 v222, v91, v89, s61
    v_perm_b32 v219, v95, v93, s60
    v_perm_b32 v223, v95, v93, s61
    v_mfma_f32_16x16x32_bf16 v[20:23], v[208:211], v[48:51], 0
    v_mfma_f32_16x16x32_bf16 v[28:31], v[212:215], v[48:51], 0
    v_mfma_f32_16x16x32_bf16 v[36:39], v[216:219], v[48:51], 0
    v_mfma_f32_16x16x32_bf16 v[44:47], v[220:223], v[48:51], 0
    v_perm_b32 v192, v98, v96, s60
    v_perm_b32 v196, v98, v96, s61
    v_perm_b32 v193, v102, v100, s60
    v_perm_b32 v197, v102, v100, s61
    v_perm_b32 v194, v106, v104, s60
    v_perm_b32 v198, v106, v104, s61
    v_perm_b32 v195, v110, v108, s60
    v_perm_b32 v199, v110, v108, s61
    v_perm_b32 v200, v99, v97, s60
    v_perm_b32 v204, v99, v97, s61
    v_perm_b32 v201, v103, v101, s60
    v_perm_b32 v205, v103, v101, s61
    v_perm_b32 v202, v107, v105, s60
    v_perm_b32 v206, v107, v105, s61
    v_perm_b32 v203, v111, v109, s60
    v_perm_b32 v207, v111, v109, s61
    v_mfma_f32_16x16x32_bf16 v[16:19], v[192:195], v[52:55], v[16:19]
    v_mfma_f32_16x16x32_bf16 v[24:27], v[196:199], v[52:55], v[24:27]
    v_mfma_f32_16x16x32_bf16 v[32:35], v[200:203], v[52:55], v[32:35]
    v_mfma_f32_16x16x32_bf16 v[40:43], v[204:207], v[52:55], v[40:43]
    v_perm_b32 v208, v114, v112, s60
    v_perm_b32 v212, v114, v112, s61
    v_perm_b32 v209, v118, v116, s60
    v_perm_b32 v213, v118, v116, s61
    v_perm_b32 v210, v122, v120, s60
    v_perm_b32 v214, v122, v120, s61
    v_perm_b32 v211, v126, v124, s60
    v_perm_b32 v215, v126, v124, s61
    v_perm_b32 v216, v115, v113, s60
    v_perm_b32 v220, v115, v113, s61
    v_perm_b32 v217, v119, v117, s60
    v_perm_b32 v221, v119, v117, s61
    v_perm_b32 v218, v123, v121, s60
    v_perm_b32 v222, v123, v121, s61
    v_perm_b32 v219, v127, v125, s60
    v_perm_b32 v223, v127, v125, s61
    v_mfma_f32_16x16x32_bf16 v[20:23], v[208:211], v[52:55], v[20:23]
    v_mfma_f32_16x16x32_bf16 v[28:31], v[212:215], v[52:55], v[28:31]
    v_mfma_f32_16x16x32_bf16 v[36:39], v[216:219], v[52:55], v[36:39]
    v_mfma_f32_16x16x32_bf16 v[44:47], v[220:223], v[52:55], v[44:47]
    s_waitcnt vmcnt(0)
    v_lshrrev_b32 v3, 4, v0
    v_lshlrev_b32 v3, 13, v3
    v_and_b32 v1, 15, v0
    v_lshl_add_u32 v9, v1, 4, v3
    s_lshl_b32 s44, s54, 16
    s_lshl_b32 s3, s48, 8
    s_add_u32 s44, s44, s3
    s_mov_b32 s94, s44
    s_add_u32 s46, s94, 0
    s_nop 0
    buffer_load_dwordx4 v[64:67], v9, s[32:35], s46 offen
    s_add_u32 s46, s94, 1024
    buffer_load_dwordx4 v[68:71], v9, s[32:35], s46 offen
    s_add_u32 s46, s94, 2048
    buffer_load_dwordx4 v[72:75], v9, s[32:35], s46 offen
    s_add_u32 s46, s94, 3072
    buffer_load_dwordx4 v[76:79], v9, s[32:35], s46 offen
    s_add_u32 s46, s94, 4096
    buffer_load_dwordx4 v[80:83], v9, s[32:35], s46 offen
    s_add_u32 s46, s94, 5120
    buffer_load_dwordx4 v[84:87], v9, s[32:35], s46 offen
    s_add_u32 s46, s94, 6144
    buffer_load_dwordx4 v[88:91], v9, s[32:35], s46 offen
    s_add_u32 s46, s94, 7168
    buffer_load_dwordx4 v[92:95], v9, s[32:35], s46 offen
    s_add_u32 s46, s94, 32768
    buffer_load_dwordx4 v[96:99], v9, s[32:35], s46 offen
    s_add_u32 s46, s94, 33792
    buffer_load_dwordx4 v[100:103], v9, s[32:35], s46 offen
    s_add_u32 s46, s94, 34816
    buffer_load_dwordx4 v[104:107], v9, s[32:35], s46 offen
    s_add_u32 s46, s94, 35840
    buffer_load_dwordx4 v[108:111], v9, s[32:35], s46 offen
    s_add_u32 s46, s94, 36864
    buffer_load_dwordx4 v[112:115], v9, s[32:35], s46 offen
    s_add_u32 s46, s94, 37888
    buffer_load_dwordx4 v[116:119], v9, s[32:35], s46 offen
    s_add_u32 s46, s94, 38912
    buffer_load_dwordx4 v[120:123], v9, s[32:35], s46 offen
    s_add_u32 s46, s94, 39936
    buffer_load_dwordx4 v[124:127], v9, s[32:35], s46 offen
    v_lshrrev_b32 v63, 3, v0
    s_lshl_b32 s3, s48, 7
    v_add_u32 v63, s3, v63
    v_lshlrev_b32 v63, 10, v63
    s_lshl_b32 s3, s40, 7
    v_add_u32 v63, s3, v63
    v_bfe_u32 v1, v0, 4, 1
    v_lshlrev_b32 v1, 2, v1
    v_and_b32 v2, 7, v0
    v_xor_b32_e64 v1, v1, v2
    v_lshl_add_u32 v63, v1, 4, v63
    s_lshl_b32 s44, s48, 14
    s_nop 0
    v_perm_b32 v192, v130, v128, s60
    v_perm_b32 v196, v130, v128, s61
    v_perm_b32 v193, v134, v132, s60
    v_perm_b32 v197, v134, v132, s61
    v_perm_b32 v194, v138, v136, s60
    v_perm_b32 v198, v138, v136, s61
    v_perm_b32 v195, v142, v140, s60
    v_perm_b32 v199, v142, v140, s61
    v_perm_b32 v200, v131, v129, s60
    v_perm_b32 v204, v131, v129, s61
    v_perm_b32 v201, v135, v133, s60
    v_perm_b32 v205, v135, v133, s61
    v_perm_b32 v202, v139, v137, s60
    v_perm_b32 v206, v139, v137, s61
    v_perm_b32 v203, v143, v141, s60
    v_perm_b32 v207, v143, v141, s61
    v_mfma_f32_16x16x32_bf16 v[224:227], v[192:195], v[48:51], 0
    v_mfma_f32_16x16x32_bf16 v[232:235], v[196:199], v[48:51], 0
    v_mfma_f32_16x16x32_bf16 v[240:243], v[200:203], v[48:51], 0
    v_mfma_f32_16x16x32_bf16 v[248:251], v[204:207], v[48:51], 0
    v_perm_b32 v208, v146, v144, s60
    v_perm_b32 v212, v146, v144, s61
    v_perm_b32 v209, v150, v148, s60
    v_perm_b32 v213, v150, v148, s61
    v_perm_b32 v210, v154, v152, s60
    v_perm_b32 v214, v154, v152, s61
    v_perm_b32 v211, v158, v156, s60
    v_perm_b32 v215, v158, v156, s61
    v_perm_b32 v216, v147, v145, s60
    v_perm_b32 v220, v147, v145, s61
    v_perm_b32 v217, v151, v149, s60
    v_perm_b32 v221, v151, v149, s61
    v_perm_b32 v218, v155, v153, s60
    v_perm_b32 v222, v155, v153, s61
    v_perm_b32 v219, v159, v157, s60
    v_perm_b32 v223, v159, v157, s61
    v_mfma_f32_16x16x32_bf16 v[228:231], v[208:211], v[48:51], 0
    v_mfma_f32_16x16x32_bf16 v[236:239], v[212:215], v[48:51], 0
    v_mfma_f32_16x16x32_bf16 v[244:247], v[216:219], v[48:51], 0
    v_mfma_f32_16x16x32_bf16 v[252:255], v[220:223], v[48:51], 0
    v_perm_b32 v192, v162, v160, s60
    v_perm_b32 v196, v162, v160, s61
    v_perm_b32 v193, v166, v164, s60
    v_perm_b32 v197, v166, v164, s61
    v_perm_b32 v194, v170, v168, s60
    v_perm_b32 v198, v170, v168, s61
    v_perm_b32 v195, v174, v172, s60
    v_perm_b32 v199, v174, v172, s61
    v_perm_b32 v200, v163, v161, s60
    v_perm_b32 v204, v163, v161, s61
    v_perm_b32 v201, v167, v165, s60
    v_perm_b32 v205, v167, v165, s61
    v_perm_b32 v202, v171, v169, s60
    v_perm_b32 v206, v171, v169, s61
    v_perm_b32 v203, v175, v173, s60
    v_perm_b32 v207, v175, v173, s61
    v_mfma_f32_16x16x32_bf16 v[224:227], v[192:195], v[52:55], v[224:227]
    v_mfma_f32_16x16x32_bf16 v[232:235], v[196:199], v[52:55], v[232:235]
    v_mfma_f32_16x16x32_bf16 v[240:243], v[200:203], v[52:55], v[240:243]
    v_mfma_f32_16x16x32_bf16 v[248:251], v[204:207], v[52:55], v[248:251]
    v_perm_b32 v208, v178, v176, s60
    v_perm_b32 v212, v178, v176, s61
    v_perm_b32 v209, v182, v180, s60
    v_perm_b32 v213, v182, v180, s61
    v_perm_b32 v210, v186, v184, s60
    v_perm_b32 v214, v186, v184, s61
    v_perm_b32 v211, v190, v188, s60
    v_perm_b32 v215, v190, v188, s61
    v_perm_b32 v216, v179, v177, s60
    v_perm_b32 v220, v179, v177, s61
    v_perm_b32 v217, v183, v181, s60
    v_perm_b32 v221, v183, v181, s61
    v_perm_b32 v218, v187, v185, s60
    v_perm_b32 v222, v187, v185, s61
    v_perm_b32 v219, v191, v189, s60
    v_perm_b32 v223, v191, v189, s61
    v_mfma_f32_16x16x32_bf16 v[228:231], v[208:211], v[52:55], v[228:231]
    v_mfma_f32_16x16x32_bf16 v[236:239], v[212:215], v[52:55], v[236:239]
    v_mfma_f32_16x16x32_bf16 v[244:247], v[216:219], v[52:55], v[244:247]
    v_mfma_f32_16x16x32_bf16 v[252:255], v[220:223], v[52:55], v[252:255]
    v_add_f32_dpp v16, v20, v16 row_ror:8 row_mask:0xf bank_mask:0xf
    v_add_f32_dpp v17, v21, v17 row_ror:8 row_mask:0xf bank_mask:0xf
    v_add_f32_dpp v18, v22, v18 row_ror:8 row_mask:0xf bank_mask:0xf
    v_add_f32_dpp v19, v23, v19 row_ror:8 row_mask:0xf bank_mask:0xf
    v_add_f32_dpp v24, v28, v24 row_ror:8 row_mask:0xf bank_mask:0xf
    v_add_f32_dpp v25, v29, v25 row_ror:8 row_mask:0xf bank_mask:0xf
    v_add_f32_dpp v26, v30, v26 row_ror:8 row_mask:0xf bank_mask:0xf
    v_add_f32_dpp v27, v31, v27 row_ror:8 row_mask:0xf bank_mask:0xf
    v_add_f32_dpp v32, v36, v32 row_ror:8 row_mask:0xf bank_mask:0xf
    v_add_f32_dpp v33, v37, v33 row_ror:8 row_mask:0xf bank_mask:0xf
    v_add_f32_dpp v34, v38, v34 row_ror:8 row_mask:0xf bank_mask:0xf
    v_add_f32_dpp v35, v39, v35 row_ror:8 row_mask:0xf bank_mask:0xf
    v_add_f32_dpp v40, v44, v40 row_ror:8 row_mask:0xf bank_mask:0xf
    v_add_f32_dpp v41, v45, v41 row_ror:8 row_mask:0xf bank_mask:0xf
    v_add_f32_dpp v42, v46, v42 row_ror:8 row_mask:0xf bank_mask:0xf
    v_add_f32_dpp v43, v47, v43 row_ror:8 row_mask:0xf bank_mask:0xf
    v_add_f32_dpp v224, v228, v224 row_ror:8 row_mask:0xf bank_mask:0xf
    v_add_f32_dpp v225, v229, v225 row_ror:8 row_mask:0xf bank_mask:0xf
    v_add_f32_dpp v226, v230, v226 row_ror:8 row_mask:0xf bank_mask:0xf
    v_add_f32_dpp v227, v231, v227 row_ror:8 row_mask:0xf bank_mask:0xf
    v_add_f32_dpp v232, v236, v232 row_ror:8 row_mask:0xf bank_mask:0xf
    v_add_f32_dpp v233, v237, v233 row_ror:8 row_mask:0xf bank_mask:0xf
    v_add_f32_dpp v234, v238, v234 row_ror:8 row_mask:0xf bank_mask:0xf
    v_add_f32_dpp v235, v239, v235 row_ror:8 row_mask:0xf bank_mask:0xf
    v_add_f32_dpp v240, v244, v240 row_ror:8 row_mask:0xf bank_mask:0xf
    v_add_f32_dpp v241, v245, v241 row_ror:8 row_mask:0xf bank_mask:0xf
    v_add_f32_dpp v242, v246, v242 row_ror:8 row_mask:0xf bank_mask:0xf
    v_add_f32_dpp v243, v247, v243 row_ror:8 row_mask:0xf bank_mask:0xf
    v_add_f32_dpp v248, v252, v248 row_ror:8 row_mask:0xf bank_mask:0xf
    v_add_f32_dpp v249, v253, v249 row_ror:8 row_mask:0xf bank_mask:0xf
    v_add_f32_dpp v250, v254, v250 row_ror:8 row_mask:0xf bank_mask:0xf
    v_add_f32_dpp v251, v255, v251 row_ror:8 row_mask:0xf bank_mask:0xf
    v_lshrrev_b32 v1, 4, v0
    v_lshlrev_b32 v1, 3, v1
    v_and_b32 v2, 7, v0
    v_add_u32 v1, v1, v2
    v_lshlrev_b32 v13, 4, v1
    s_lshl_b32 s3, s48, 12
    s_add_u32 s3, s3, 65536
    v_add_u32_e64 v1, s3, v13
    s_mov_b32 s58, 0x00ff00ff
    s_mov_b32 s59, 0x00ff00ff
    s_mov_b64 exec, s[58:59]
    s_nop 0
    ds_write_b128 v1, v[16:19] offset:0
    ds_write_b128 v1, v[24:27] offset:512
    ds_write_b128 v1, v[32:35] offset:1024
    ds_write_b128 v1, v[40:43] offset:1536
    ds_write_b128 v1, v[224:227] offset:2048
    ds_write_b128 v1, v[232:235] offset:2560
    ds_write_b128 v1, v[240:243] offset:3072
    ds_write_b128 v1, v[248:251] offset:3584
    s_mov_b64 exec, -1
    s_waitcnt lgkmcnt(0)
    v_mov_b32 v1, 157188
    v_mov_b32 v2, 1
    s_mov_b64 exec, 1
    ds_add_u32 v1, v2
    s_mov_b64 exec, -1
    s_waitcnt vmcnt(0)
    v_perm_b32 v128, v68, v64, s60
    v_perm_b32 v132, v68, v64, s61
    v_perm_b32 v129, v76, v72, s60
    v_perm_b32 v133, v76, v72, s61
    v_perm_b32 v130, v84, v80, s60
    v_perm_b32 v134, v84, v80, s61
    v_perm_b32 v131, v92, v88, s60
    v_perm_b32 v135, v92, v88, s61
    v_perm_b32 v136, v69, v65, s60
    v_perm_b32 v140, v69, v65, s61
    v_perm_b32 v137, v77, v73, s60
    v_perm_b32 v141, v77, v73, s61
    v_perm_b32 v138, v85, v81, s60
    v_perm_b32 v142, v85, v81, s61
    v_perm_b32 v139, v93, v89, s60
    v_perm_b32 v143, v93, v89, s61
    v_perm_b32 v144, v70, v66, s60
    v_perm_b32 v148, v70, v66, s61
    v_perm_b32 v145, v78, v74, s60
    v_perm_b32 v149, v78, v74, s61
    v_perm_b32 v146, v86, v82, s60
    v_perm_b32 v150, v86, v82, s61
    v_perm_b32 v147, v94, v90, s60
    v_perm_b32 v151, v94, v90, s61
    v_perm_b32 v152, v71, v67, s60
    v_perm_b32 v156, v71, v67, s61
    v_perm_b32 v153, v79, v75, s60
    v_perm_b32 v157, v79, v75, s61
    v_perm_b32 v154, v87, v83, s60
    v_perm_b32 v158, v87, v83, s61
    v_perm_b32 v155, v95, v91, s60
    v_perm_b32 v159, v95, v91, s61
    v_perm_b32 v160, v100, v96, s60
    v_perm_b32 v164, v100, v96, s61
    v_perm_b32 v161, v108, v104, s60
    v_perm_b32 v165, v108, v104, s61
    v_perm_b32 v162, v116, v112, s60
    v_perm_b32 v166, v116, v112, s61
    v_perm_b32 v163, v124, v120, s60
    v_perm_b32 v167, v124, v120, s61
    v_perm_b32 v168, v101, v97, s60
    v_perm_b32 v172, v101, v97, s61
    v_perm_b32 v169, v109, v105, s60
    v_perm_b32 v173, v109, v105, s61
    v_perm_b32 v170, v117, v113, s60
    v_perm_b32 v174, v117, v113, s61
    v_perm_b32 v171, v125, v121, s60
    v_perm_b32 v175, v125, v121, s61
    v_perm_b32 v176, v102, v98, s60
    v_perm_b32 v180, v102, v98, s61
    v_perm_b32 v177, v110, v106, s60
    v_perm_b32 v181, v110, v106, s61
    v_perm_b32 v178, v118, v114, s60
    v_perm_b32 v182, v118, v114, s61
    v_perm_b32 v179, v126, v122, s60
    v_perm_b32 v183, v126, v122, s61
    v_perm_b32 v184, v103, v99, s60
    v_perm_b32 v188, v103, v99, s61
    v_perm_b32 v185, v111, v107, s60
    v_perm_b32 v189, v111, v107, s61
    v_perm_b32 v186, v119, v115, s60
    v_perm_b32 v190, v119, v115, s61
    v_perm_b32 v187, v127, v123, s60
    v_perm_b32 v191, v127, v123, s61
    v_mov_b32 v1, 157188
    s_mov_b32 s58, 160000
L14_ts:
    ds_read_b32 v3, v1
    s_waitcnt lgkmcnt(0)
    v_readfirstlane_b32 s3, v3
    s_nop 1
    s_cmp_ge_u32 s3, 4
    s_cbranch_scc1 L15_tsd
    s_sleep 1
    s_sub_u32 s58, s58, 1
    s_cmp_lg_u32 s58, 0
    s_cbranch_scc1 L14_ts
L15_tsd:
    s_lshl_b32 s3, s48, 9
    s_add_u32 s3, s3, 65536
    v_add_u32_e64 v1, s3, v13
    ds_read_b128 v[16:19], v1 offset:0
    ds_read_b128 v[32:35], v1 offset:2048
    ds_read_b128 v[20:23], v1 offset:4096
    ds_read_b128 v[36:39], v1 offset:6144
    ds_read_b128 v[24:27], v1 offset:8192
    ds_read_b128 v[40:43], v1 offset:10240
    ds_read_b128 v[28:31], v1 offset:12288
    ds_read_b128 v[44:47], v1 offset:14336
    s_waitcnt lgkmcnt(0)
    v_add_f32 v16, v16, v20
    v_add_f32 v24, v24, v28
    v_add_f32 v16, v16, v24
    v_add_f32 v32, v32, v36
    v_add_f32 v40, v40, v44
    v_add_f32 v32, v32, v40
    v_add_f32 v17, v17, v21
    v_add_f32 v25, v25, v29
    v_add_f32 v17, v17, v25
    v_add_f32 v33, v33, v37
    v_add_f32 v41, v41, v45
    v_add_f32 v33, v33, v41
    v_add_f32 v18, v18, v22
    v_add_f32 v26, v26, v30
    v_add_f32 v18, v18, v26
    v_add_f32 v34, v34, v38
    v_add_f32 v42, v42, v46
    v_add_f32 v34, v34, v42
    v_add_f32 v19, v19, v23
    v_add_f32 v27, v27, v31
    v_add_f32 v19, v19, v27
    v_add_f32 v35, v35, v39
    v_add_f32 v43, v43, v47
    v_add_f32_e64 v35, v35, v43
    v_cvt_pk_bf16_f32 v16, 0, v16
    v_cvt_pk_bf16_f32 v32, 0, v32
    v_mul_f32 v1, 0xbfb8aa3b, v16
    v_exp_f32 v1, v1
    s_nop 0
    v_add_f32 v1, 1.0, v1
    v_rcp_f32 v1, v1
    s_nop 0
    v_mul_f32 v1, v1, v16
    v_cvt_pk_bf16_f32 v1, 0, v1
    v_mul_f32_e64 v16, v1, v32
    v_cvt_pk_bf16_f32 v16, v16, 0
    v_cvt_pk_bf16_f32 v17, 0, v17
    v_cvt_pk_bf16_f32 v33, 0, v33
    v_mul_f32 v1, 0xbfb8aa3b, v17
    v_exp_f32 v1, v1
    s_nop 0
    v_add_f32 v1, 1.0, v1
    v_rcp_f32 v1, v1
    s_nop 0
    v_mul_f32 v1, v1, v17
    v_cvt_pk_bf16_f32 v1, 0, v1
    v_mul_f32_e64 v17, v1, v33
    v_cvt_pk_bf16_f32 v17, v17, 0
    v_cvt_pk_bf16_f32 v18, 0, v18
    v_cvt_pk_bf16_f32 v34, 0, v34
    v_mul_f32 v1, 0xbfb8aa3b, v18
    v_exp_f32 v1, v1
    s_nop 0
    v_add_f32 v1, 1.0, v1
    v_rcp_f32 v1, v1
    s_nop 0
    v_mul_f32 v1, v1, v18
    v_cvt_pk_bf16_f32 v1, 0, v1
    v_mul_f32_e64 v18, v1, v34
    v_cvt_pk_bf16_f32 v18, v18, 0
    v_cvt_pk_bf16_f32 v19, 0, v19
    v_cvt_pk_bf16_f32 v35, 0, v35
    v_mul_f32 v1, 0xbfb8aa3b, v19
    v_exp_f32 v1, v1
    s_nop 0
    v_add_f32 v1, 1.0, v1
    v_rcp_f32 v1, v1
    s_nop 0
    v_mul_f32 v1, v1, v19
    v_cvt_pk_bf16_f32 v1, 0, v1
    v_mul_f32_e64 v19, v1, v35
    v_cvt_pk_bf16_f32 v19, v19, 0
    v_and_b32_e64 v1, 15, v0
    v_mul_u32_u24 v1, 0x90, v1
    v_lshrrev_b32_e64 v2, 4, v0
    v_lshl_add_u32 v1, v2, 5, v1
    s_lshl_b32 s3, s48, 1
    s_add_u32 s3, s3, 158208
    v_add_u32 v1, s3, v1
    ds_write_b16 v1, v16 offset:0
    ds_write_b16 v1, v17 offset:8
    ds_write_b16 v1, v18 offset:16
    ds_write_b16 v1, v19 offset:24
    s_waitcnt lgkmcnt(0)
    v_mov_b32 v1, 157192
    v_mov_b32_e64 v2, 1
    s_mov_b64 exec, 1
    ds_add_u32 v1, v2
    s_mov_b64 exec, -1
    s_mov_b32 s58, 160000
L16_ts:
    ds_read_b32 v3, v1
    s_waitcnt lgkmcnt(0)
    v_readfirstlane_b32 s3, v3
    s_nop 1
    s_cmp_ge_u32 s3, 4
    s_cbranch_scc1 L17_tsd
    s_sleep 1
    s_sub_u32 s58, s58, 1
    s_cmp_lg_u32 s58, 0
    s_cbranch_scc1 L16_ts
L17_tsd:
    v_and_b32_e64 v1, 15, v0
    v_mul_u32_u24 v1, 0x90, v1
    v_lshrrev_b32_e64 v2, 4, v0
    v_lshl_add_u32 v1, v2, 4, v1
    v_add_u32 v1, 158208, v1
    ds_read_b128 v[48:51], v1
    ds_read_b128 v[52:55], v1 offset:64
    v_and_b32 v12, 15, v0
    v_lshlrev_b32 v12, 11, v12
    v_lshrrev_b32_e64 v13, 4, v0
    v_lshl_add_u32 v12, v13, 4, v12
    s_lshl_b32 s56, s54, 14
    s_lshl_b32 s57, s48, 9
    s_add_u32 s56, s56, s57
    s_add_u32 s56, s56, 0xa30000
    s_waitcnt lgkmcnt(0)
    v_mfma_f32_16x16x32_bf16 v[16:19], v[128:131], v[48:51], 0
    v_mfma_f32_16x16x32_bf16 v[16:19], v[160:163], v[52:55], v[16:19]
    v_mfma_f32_16x16x32_bf16 v[20:23], v[132:135], v[48:51], 0
    v_mfma_f32_16x16x32_bf16 v[20:23], v[164:167], v[52:55], v[20:23]
    v_mfma_f32_16x16x32_bf16 v[24:27], v[136:139], v[48:51], 0
    v_mfma_f32_16x16x32_bf16 v[24:27], v[168:171], v[52:55], v[24:27]
    v_mfma_f32_16x16x32_bf16 v[28:31], v[140:143], v[48:51], 0
    v_mfma_f32_16x16x32_bf16 v[28:31], v[172:175], v[52:55], v[28:31]
    v_mfma_f32_16x16x32_bf16 v[32:35], v[144:147], v[48:51], 0
    v_mfma_f32_16x16x32_bf16 v[32:35], v[176:179], v[52:55], v[32:35]
    v_mfma_f32_16x16x32_bf16 v[36:39], v[148:151], v[48:51], 0
    v_mfma_f32_16x16x32_bf16 v[36:39], v[180:183], v[52:55], v[36:39]
    v_mfma_f32_16x16x32_bf16 v[40:43], v[152:155], v[48:51], 0
    v_mfma_f32_16x16x32_bf16 v[40:43], v[184:187], v[52:55], v[40:43]
    v_mfma_f32_16x16x32_bf16 v[44:47], v[156:159], v[48:51], 0
    v_mfma_f32_16x16x32_bf16 v[44:47], v[188:191], v[52:55], v[44:47]
    s_mov_b32 s58, 0x00ff00ff
    s_mov_b32 s59, 0x00ff00ff
    s_mov_b64 exec, s[58:59]
    s_nop 0
    buffer_store_dwordx4 v[16:19], v12, s[12:15], s56 offen offset:0 sc1
    buffer_store_dwordx4 v[20:23], v12, s[12:15], s56 offen offset:64 sc1
    buffer_store_dwordx4 v[24:27], v12, s[12:15], s56 offen offset:128 sc1
    buffer_store_dwordx4 v[28:31], v12, s[12:15], s56 offen offset:192 sc1
    buffer_store_dwordx4 v[32:35], v12, s[12:15], s56 offen offset:256 sc1
    buffer_store_dwordx4 v[36:39], v12, s[12:15], s56 offen offset:320 sc1
    buffer_store_dwordx4 v[40:43], v12, s[12:15], s56 offen offset:384 sc1
    buffer_store_dwordx4 v[44:47], v12, s[12:15], s56 offen offset:448 sc1
    s_mov_b64 exec, -1
    s_lshl_b32 s3, s38, 6
    v_add_u32 v208, s3, v0
    v_lshrrev_b32 v1, 3, v208
    s_lshl_b32 s3, s39, 6
    v_add_u32 v1, s3, v1
    v_lshlrev_b32 v1, 10, v1
    v_and_b32 v2, 7, v208
    v_lshl_add_u32 v1, v2, 4, v1
    s_lshl_b32 s3, s40, 7
    v_add_u32 v209, s3, v1
    buffer_load_dwordx4 v[200:203], v209, s[4:7], 0 offen
    v_lshrrev_b32 v1, 3, v208
    v_lshlrev_b32 v1, 2, v1
    v_add_u32 v1, 156672, v1
    ds_read_b32 v210, v1
    ds_read_b32 v211, v1 offset:256
    v_mov_b32 v1, 157196
    v_mov_b32_e64 v2, 1
    v_mov_b32 v4, 157208
    s_waitcnt vmcnt(0)
    s_mov_b64 exec, 1
    ds_add_rtn_u32 v3, v1, v2
    s_waitcnt lgkmcnt(0)
    v_readfirstlane_b32 s3, v3
    s_mov_b64 exec, -1
    s_nop 0
    s_cmp_lg_u32 s3, 3
    s_cbranch_scc1 L_fl_p3
    s_lshl_b32 s3, s54, 7
    s_add_u32 s3, s3, 0xa20000
    v_mov_b32 v2, s3
    v_mov_b32 v3, s41
    s_mov_b64 exec, 1
    buffer_store_dword v3, v2, s[12:15], 0 offen sc1
    s_mov_b64 exec, -1
    s_branch L_fl_p3
L_crest:
    s_and_b32 s43, s38, 1
    s_lshr_b32 s44, s38, 1
    v_and_b32 v1, 31, v0
    s_lshl_b32 s3, s43, 12
    v_lshlrev_b32 v1, 7, v1
    v_add_u32 v1, s3, v1
    v_bfe_u32 v8, v0, 1, 3
    v_lshrrev_b32 v9, 5, v0
    v_xor_b32 v8, v8, v9
    s_lshl_b32 s3, s43, 2
    v_xor_b32 v8, s3, v8
    v_lshl_add_u32 v2, v8, 4, v1
    v_xor_b32 v3, 32, v2
    v_xor_b32 v4, 64, v2
    v_xor_b32 v5, 0x60, v2
    v_lshrrev_b32 v1, 5, v0
    v_lshlrev_b32 v1, 3, v1
    v_bfe_u32 v8, v0, 2, 2
    v_add_u32 v1, v1, v8
    v_lshlrev_b32 v6, 7, v1
    v_bfe_u32 v1, v0, 4, 1
    v_lshlrev_b32_e64 v1, 1, v1
    v_bfe_u32 v8, v0, 1, 1
    v_add_u32 v1, v1, v8
    s_lshl_b32 s3, s44, 2
    v_add_u32_e64 v1, s3, v1
    v_bfe_u32 v8, v0, 3, 1
    v_lshlrev_b32 v8, 2, v8
    v_xor_b32 v1, v1, v8
    v_lshl_add_u32 v6, v1, 4, v6
    v_and_b32_e64 v1, 1, v0
    v_lshl_add_u32 v6, v1, 3, v6
    v_add_u32 v6, 0x2000, v6
    s_lshl_b32 s3, s43, 12
    v_subrev_u32 v7, s3, v6
    v_add_u32 v6, s3, v6
    v_and_b32 v1, 15, v0
    v_bfe_u32 v8, v0, 4, 1
    v_cmp_eq_u32 s[48:49], v1, v8
    v_mov_b32 v8, 0x3f803f80
    v_mov_b32_e64 v9, 0
    v_cndmask_b32 v40, v9, v8, s[48:49]
    v_mov_b32 v41, v40
    v_mov_b32 v42, v40
    v_mov_b32 v43, v40
    v_mov_b32 v48, 0
    v_mov_b32 v49, 0
    v_mov_b32 v50, 0
    v_mov_b32 v51, 0
    v_mov_b32 v52, 0
    v_mov_b32 v53, 0
    v_mov_b32 v54, 0
    v_mov_b32 v55, 0
    v_mov_b32 v56, 0
    v_mov_b32 v57, 0
    v_mov_b32 v58, 0
    v_mov_b32 v59, 0
    v_mov_b32 v60, 0
    v_mov_b32 v61, 0
    v_mov_b32 v62, 0
    v_mov_b32 v63, 0
    v_mov_b32 v64, 0
    v_mov_b32 v65, 0
    v_mov_b32 v66, 0
    v_mov_b32 v67, 0
    v_mov_b32 v68, 0
    v_mov_b32 v69, 0
    v_mov_b32 v70, 0
    v_mov_b32 v71, 0
    v_mov_b32 v72, 0
    v_mov_b32 v73, 0
    v_mov_b32 v74, 0
    v_mov_b32 v75, 0
    v_mov_b32 v76, 0
    v_mov_b32 v77, 0
    v_mov_b32 v78, 0
    v_mov_b32 v79, 0
    v_mov_b32 v80, 0
    v_mov_b32 v81, 0
    v_mov_b32 v82, 0
    v_mov_b32 v83, 0
    v_mov_b32 v84, 0
    v_mov_b32 v85, 0
    v_mov_b32 v86, 0
    v_mov_b32 v87, 0
    v_mov_b32 v88, 0
    v_mov_b32 v89, 0
    v_mov_b32 v90, 0
    v_mov_b32 v91, 0
    v_mov_b32 v92, 0
    v_mov_b32 v93, 0
    v_mov_b32 v94, 0
    v_mov_b32 v95, 0
    v_mov_b32 v100, 0
    v_mov_b32 v101, 0
    v_mov_b32 v102, 0
    v_mov_b32 v103, 0
    v_mov_b32 v104, 0
    v_mov_b32 v105, 0
    v_mov_b32 v106, 0
    v_mov_b32 v107, 0
    v_mov_b32 v108, 0
    v_mov_b32 v109, 0
    v_mov_b32 v110, 0
    v_mov_b32_e64 v111, 0
    s_mul_i32 s3, s38, 192
    s_add_u32 s3, s3, 155648
    v_lshl_add_u32 v1, v0, 2, s3
    s_mov_b32 exec_hi, 0xffff
    ds_write_b32 v1, v48
    s_mov_b64 exec, -1
    s_nop 0
    v_mov_b32 v1, 157184
    ds_write_b128 v1, v[48:51]
    ds_write_b128 v1, v[48:51] offset:16
    ds_write_b128 v1, v[48:51] offset:32
    s_waitcnt vmcnt(0)
    v_lshlrev_b32 v112, 16, v180
    v_and_b32 v113, 0xffff0000, v180
    v_lshlrev_b32_e64 v114, 16, v181
    v_and_b32 v115, 0xffff0000, v181
    v_lshlrev_b32_e64 v116, 16, v182
    v_and_b32 v117, 0xffff0000, v182
    v_lshlrev_b32_e64 v118, 16, v183
    v_and_b32 v119, 0xffff0000, v183
    v_lshlrev_b32_e64 v120, 16, v184
    v_and_b32 v121, 0xffff0000, v184
    v_lshlrev_b32_e64 v122, 16, v185
    v_and_b32 v123, 0xffff0000, v185
    v_lshlrev_b32_e64 v124, 16, v186
    v_and_b32 v125, 0xffff0000, v186
    v_lshlrev_b32_e64 v126, 16, v187
    v_and_b32 v127, 0xffff0000, v187
    v_add_f32 v144, v112, v113
    v_add_f32 v145, v114, v115
    v_add_f32 v144, v144, v116
    v_add_f32 v145, v145, v117
    v_add_f32 v144, v144, v118
    v_add_f32 v145, v145, v119
    v_add_f32 v144, v144, v120
    v_add_f32 v145, v145, v121
    v_add_f32 v144, v144, v122
    v_add_f32 v145, v145, v123
    v_add_f32 v144, v144, v124
    v_add_f32 v145, v145, v125
    v_add_f32 v144, v144, v126
    v_add_f32 v145, v145, v127
    v_add_f32 v144, v144, v145
    s_nop 1
    v_add_f32_dpp v144, v144, v144 quad_perm:[1,0,3,2] row_mask:0xf bank_mask:0xf
    s_nop 1
    v_add_f32_dpp v144, v144, v144 quad_perm:[2,3,0,1] row_mask:0xf bank_mask:0xf
    s_nop 1
    v_add_f32_dpp v144, v144, v144 row_half_mirror row_mask:0xf bank_mask:0xf
    s_nop 1
    v_add_f32_dpp v144, v144, v144 row_mirror row_mask:0xf bank_mask:0xf
    v_mov_b32 v145, v144
    s_nop 1
    v_permlane16_swap_b32 v144, v145
    v_add_f32_e64 v144, v144, v145
    v_mul_f32 v146, 0x3b000000, v144
    v_sub_f32 v128, v112, v146
    v_sub_f32 v129, v113, v146
    v_sub_f32 v130, v114, v146
    v_sub_f32 v131, v115, v146
    v_sub_f32 v132, v116, v146
    v_sub_f32 v133, v117, v146
    v_sub_f32 v134, v118, v146
    v_sub_f32 v135, v119, v146
    v_sub_f32 v136, v120, v146
    v_sub_f32 v137, v121, v146
    v_sub_f32 v138, v122, v146
    v_sub_f32 v139, v123, v146
    v_sub_f32 v140, v124, v146
    v_sub_f32 v141, v125, v146
    v_sub_f32 v142, v126, v146
    v_sub_f32 v143, v127, v146
    v_mul_f32 v144, v128, v128
    v_mul_f32 v145, v129, v129
    v_fmac_f32 v144, v130, v130
    v_fmac_f32 v145, v131, v131
    v_fmac_f32 v144, v132, v132
    v_fmac_f32 v145, v133, v133
    v_fmac_f32 v144, v134, v134
    v_fmac_f32 v145, v135, v135
    v_fmac_f32 v144, v136, v136
    v_fmac_f32 v145, v137, v137
    v_fmac_f32 v144, v138, v138
    v_fmac_f32 v145, v139, v139
    v_fmac_f32 v144, v140, v140
    v_fmac_f32 v145, v141, v141
    v_fmac_f32 v144, v142, v142
    v_fmac_f32 v145, v143, v143
    v_add_f32 v144, v144, v145
    s_nop 1
    v_add_f32_dpp v144, v144, v144 quad_perm:[1,0,3,2] row_mask:0xf bank_mask:0xf
    s_nop 1
    v_add_f32_dpp v144, v144, v144 quad_perm:[2,3,0,1] row_mask:0xf bank_mask:0xf
    s_nop 1
    v_add_f32_dpp v144, v144, v144 row_half_mirror row_mask:0xf bank_mask:0xf
    s_nop 1
    v_add_f32_dpp v144, v144, v144 row_mirror row_mask:0xf bank_mask:0xf
    v_mov_b32 v145, v144
    s_nop 1
    v_permlane16_swap_b32 v144, v145
    v_add_f32_e64 v144, v144, v145
    v_mul_f32 v144, 0x3b000000, v144
    v_cvt_pk_bf16_f32 v147, 0, v146
    v_cvt_pk_bf16_f32 v145, 0, v144
    v_add_f32 v145, 0x3727c5ac, v145
    v_cvt_pk_bf16_f32 v145, 0, v145
    v_sqrt_f32 v145, v145
    s_nop 0
    v_cvt_pk_bf16_f32 v150, 0, v145
    v_rcp_f32 v148, v150
    v_lshrrev_b32 v145, 16, v147
    v_or_b32 v152, v150, v145
    s_waitcnt lgkmcnt(0)
    s_add_u32 s41, s41, 1
    v_mov_b32 v153, s41
    v_mov_b32 v151, 157248
    ds_write_b32 v151, v153
    v_lshlrev_b32_e64 v178, 3, v176
    v_add_u32 v151, 0xa05000, v178
    s_mov_b32 s48, 1
    s_mov_b32 s49, 1
    s_mov_b64 exec, s[48:49]
    buffer_store_dwordx2 v[152:153], v151, s[12:15], 0 offen sc1
    s_mov_b64 exec, -1
    v_sub_f32 v112, v112, v147
    v_sub_f32 v113, v113, v147
    v_sub_f32 v114, v114, v147
    v_sub_f32 v115, v115, v147
    v_sub_f32 v116, v116, v147
    v_sub_f32 v117, v117, v147
    v_sub_f32 v118, v118, v147
    v_sub_f32 v119, v119, v147
    v_sub_f32 v120, v120, v147
    v_sub_f32 v121, v121, v147
    v_sub_f32 v122, v122, v147
    v_sub_f32 v123, v123, v147
    v_sub_f32 v124, v124, v147
    v_sub_f32 v125, v125, v147
    v_sub_f32 v126, v126, v147
    v_sub_f32 v127, v127, v147
    v_cvt_pk_bf16_f32 v128, v112, v113
    v_cvt_pk_bf16_f32 v129, v114, v115
    v_cvt_pk_bf16_f32 v130, v116, v117
    v_cvt_pk_bf16_f32 v131, v118, v119
    v_cvt_pk_bf16_f32 v132, v120, v121
    v_cvt_pk_bf16_f32 v133, v122, v123
    v_cvt_pk_bf16_f32 v134, v124, v125
    v_cvt_pk_bf16_f32 v135, v126, v127
    v_lshlrev_b32_e64 v112, 16, v128
    v_and_b32 v113, 0xffff0000, v128
    v_lshlrev_b32_e64 v114, 16, v129
    v_and_b32 v115, 0xffff0000, v129
    v_lshlrev_b32_e64 v116, 16, v130
    v_and_b32 v117, 0xffff0000, v130
    v_lshlrev_b32_e64 v118, 16, v131
    v_and_b32 v119, 0xffff0000, v131
    v_lshlrev_b32_e64 v120, 16, v132
    v_and_b32 v121, 0xffff0000, v132
    v_lshlrev_b32_e64 v122, 16, v133
    v_and_b32 v123, 0xffff0000, v133
    v_lshlrev_b32_e64 v124, 16, v134
    v_and_b32 v125, 0xffff0000, v134
    v_lshlrev_b32_e64 v126, 16, v135
    v_and_b32 v127, 0xffff0000, v135
    v_mul_f32 v112, v148, v112
    v_mul_f32 v113, v148, v113
    v_mul_f32 v114, v148, v114
    v_mul_f32 v115, v148, v115
    v_mul_f32 v116, v148, v116
    v_mul_f32 v117, v148, v117
    v_mul_f32 v118, v148, v118
    v_mul_f32 v119, v148, v119
    v_mul_f32 v120, v148, v120
    v_mul_f32 v121, v148, v121
    v_mul_f32 v122, v148, v122
    v_mul_f32 v123, v148, v123
    v_mul_f32 v124, v148, v124
    v_mul_f32 v125, v148, v125
    v_mul_f32 v126, v148, v126
    v_mul_f32 v127, v148, v127
    v_cvt_pk_bf16_f32 v180, v112, v113
    v_cvt_pk_bf16_f32 v181, v114, v115
    v_cvt_pk_bf16_f32 v182, v116, v117
    v_cvt_pk_bf16_f32 v183, v118, v119
    v_cvt_pk_bf16_f32 v184, v120, v121
    v_cvt_pk_bf16_f32 v185, v122, v123
    v_cvt_pk_bf16_f32 v186, v124, v125
    v_cvt_pk_bf16_f32 v187, v126, v127
    v_mov_b32 v149, 0
    v_dot2c_f32_bf16 v149, v180, v188
    v_dot2c_f32_bf16 v149, v181, v189
    v_dot2c_f32_bf16 v149, v182, v190
    v_dot2c_f32_bf16 v149, v183, v191
    v_dot2c_f32_bf16 v149, v184, v192
    v_dot2c_f32_bf16 v149, v185, v193
    v_dot2c_f32_bf16 v149, v186, v194
    v_dot2c_f32_bf16 v149, v187, v195
    s_nop 2
    v_add_f32_dpp v149, v149, v149 quad_perm:[1,0,3,2] row_mask:0xf bank_mask:0xf
    s_nop 1
    v_add_f32_dpp v149, v149, v149 quad_perm:[2,3,0,1] row_mask:0xf bank_mask:0xf
    s_nop 1
    v_add_f32_dpp v149, v149, v149 row_half_mirror row_mask:0xf bank_mask:0xf
    s_nop 1
    v_add_f32_dpp v149, v149, v149 row_mirror row_mask:0xf bank_mask:0xf
    v_mov_b32 v145, v149
    s_nop 1
    v_permlane16_swap_b32 v149, v145
    v_add_f32_e64 v149, v149, v145
    v_cvt_pk_bf16_f32 v149, 0, v149
    v_ashrrev_i32_e64 v145, 31, v149
    v_or_b32 v145, 0x80000000, v145
    v_xor_b32_e64 v149, v149, v145
    v_and_b32 v149, 0xffff0000, v149
    v_sub_u32 v145, 0x7ff, v176
    v_or_b32 v196, v149, v145
    v_mov_b32 v197, s41
    v_add_u32 v195, 0xa01000, v178
    s_mov_b64 exec, s[48:49]
    buffer_store_dwordx2 v[196:197], v195, s[12:15], 0 offen sc1
    s_mov_b64 exec, -1
    s_waitcnt lgkmcnt(0)
    s_barrier
    ds_read_b128 v[112:115], v2 offset:0
    ds_read_b64_tr_b16 v[120:121], v6 offset:8192
    ds_read_b64_tr_b16 v[122:123], v6 offset:8704
    ds_read_b64_tr_b16 v[124:125], v6 offset:16384
    ds_read_b64_tr_b16 v[126:127], v6 offset:16896
    ds_read_b64_tr_b16 v[116:117], v6 offset:0
    ds_read_b64_tr_b16 v[118:119], v6 offset:512
    ds_read_b128 v[128:131], v3 offset:0
    ds_read_b64_tr_b16 v[136:137], v6 offset:10240
    ds_read_b64_tr_b16 v[138:139], v6 offset:10752
    ds_read_b64_tr_b16 v[140:141], v6 offset:18432
    ds_read_b64_tr_b16 v[142:143], v6 offset:18944
    ds_read_b64_tr_b16 v[132:133], v6 offset:2048
    ds_read_b64_tr_b16 v[134:135], v6 offset:2560
    s_mov_b32 s46, 0
    s_nop 0
L_cloop:
    s_cmp_lg_u32 s46, 3
    s_cbranch_scc1 L_nogran
    s_and_b32 s47, s2, 7
    s_lshr_b32 s50, s2, 3
    s_cmp_eq_u32 s47, 7
    s_cbranch_scc1 L_nogran
    s_cmp_eq_u32 s38, 1
    s_cbranch_scc1 L2_t1
    s_cmp_lg_u32 s38, 2
    s_cbranch_scc1 L_nogran
L2_t1:
    v_lshrrev_b32 v9, 2, v0
    s_lshl_b32 s3, s50, 4
    v_add_u32_e64 v9, s3, v9
    v_mul_u32_u24 v9, 0xe00, v9
    v_and_b32_e64 v8, 3, v0
    v_lshl_add_u32 v9, v8, 7, v9
    s_lshl_b32 s3, s47, 9
    v_add_u32 v9, s3, v9
    s_cmp_eq_u32 s38, 2
    s_cbranch_scc1 L3_t2
    buffer_load_dword v199, v9, s[24:27], 0 offen
    s_branch L_nogran
L3_t2:
    buffer_load_dword v199, v9, s[28:31], 0 offen
L_nogran:
    s_waitcnt lgkmcnt(7)
    v_mfma_f32_32x32x16_bf16 v[64:79], v[120:123], v[112:115], v[64:79]
    ds_read_b128 v[144:147], v4 offset:0
    ds_read_b64_tr_b16 v[152:153], v7 offset:12288
    ds_read_b64_tr_b16 v[154:155], v7 offset:12800
    v_mfma_f32_32x32x16_bf16 v[80:95], v[112:115], v[124:127], v[80:95]
    ds_read_b64_tr_b16 v[156:157], v7 offset:20480
    ds_read_b64_tr_b16 v[158:159], v7 offset:20992
    v_mfma_f32_32x32x16_bf16 v[48:63], v[116:119], v[112:115], v[48:63]
    ds_read_b64_tr_b16 v[148:149], v7 offset:4096
    ds_read_b64_tr_b16 v[150:151], v7 offset:4608
    v_mfma_f32_16x16x32_bf16 v[100:103], v[40:43], v[116:119], v[100:103]
    v_mfma_f32_16x16x32_bf16 v[104:107], v[40:43], v[120:123], v[104:107]
    v_mfma_f32_16x16x32_bf16 v[108:111], v[40:43], v[124:127], v[108:111]
    s_waitcnt lgkmcnt(7)
    s_nop 0
    v_mfma_f32_32x32x16_bf16 v[64:79], v[136:139], v[128:131], v[64:79]
    ds_read_b128 v[160:163], v5 offset:0
    ds_read_b64_tr_b16 v[168:169], v7 offset:14336
    ds_read_b64_tr_b16 v[170:171], v7 offset:14848
    v_mfma_f32_32x32x16_bf16 v[80:95], v[128:131], v[140:143], v[80:95]
    ds_read_b64_tr_b16 v[172:173], v7 offset:22528
    ds_read_b64_tr_b16 v[174:175], v7 offset:23040
    v_mfma_f32_32x32x16_bf16 v[48:63], v[132:135], v[128:131], v[48:63]
    ds_read_b64_tr_b16 v[164:165], v7 offset:6144
    ds_read_b64_tr_b16 v[166:167], v7 offset:6656
    v_mfma_f32_16x16x32_bf16 v[100:103], v[40:43], v[132:135], v[100:103]
    v_mfma_f32_16x16x32_bf16 v[104:107], v[40:43], v[136:139], v[104:107]
    v_mfma_f32_16x16x32_bf16 v[108:111], v[40:43], v[140:143], v[108:111]
    s_waitcnt lgkmcnt(7)
    s_barrier
    v_mfma_f32_32x32x16_bf16 v[64:79], v[152:155], v[144:147], v[64:79]
    ds_read_b128 v[112:115], v2 offset:32768
    ds_read_b64_tr_b16 v[120:121], v6 offset:40960
    ds_read_b64_tr_b16 v[122:123], v6 offset:41472
    v_mfma_f32_32x32x16_bf16 v[80:95], v[144:147], v[156:159], v[80:95]
    ds_read_b64_tr_b16 v[124:125], v6 offset:49152
    ds_read_b64_tr_b16 v[126:127], v6 offset:49664
    v_mfma_f32_32x32x16_bf16 v[48:63], v[148:151], v[144:147], v[48:63]
    ds_read_b64_tr_b16 v[116:117], v6 offset:32768
    ds_read_b64_tr_b16 v[118:119], v6 offset:33280
    s_waitcnt lgkmcnt(7)
    s_nop 0
    v_mfma_f32_32x32x16_bf16 v[64:79], v[168:171], v[160:163], v[64:79]
    ds_read_b128 v[128:131], v3 offset:32768
    ds_read_b64_tr_b16 v[136:137], v6 offset:43008
    ds_read_b64_tr_b16 v[138:139], v6 offset:43520
    v_mfma_f32_32x32x16_bf16 v[80:95], v[160:163], v[172:175], v[80:95]
    ds_read_b64_tr_b16 v[140:141], v6 offset:51200
    ds_read_b64_tr_b16 v[142:143], v6 offset:51712
    v_mfma_f32_32x32x16_bf16 v[48:63], v[164:167], v[160:163], v[48:63]
    ds_read_b64_tr_b16 v[132:133], v6 offset:34816
    ds_read_b64_tr_b16 v[134:135], v6 offset:35328
    s_waitcnt lgkmcnt(7)
    s_nop 0
    v_mfma_f32_32x32x16_bf16 v[64:79], v[120:123], v[112:115], v[64:79]
    ds_read_b128 v[144:147], v4 offset:32768
    ds_read_b64_tr_b16 v[152:153], v7 offset:45056
    ds_read_b64_tr_b16 v[154:155], v7 offset:45568
    v_mfma_f32_32x32x16_bf16 v[80:95], v[112:115], v[124:127], v[80:95]
    ds_read_b64_tr_b16 v[156:157], v7 offset:53248
    ds_read_b64_tr_b16 v[158:159], v7 offset:53760
    v_mfma_f32_32x32x16_bf16 v[48:63], v[116:119], v[112:115], v[48:63]
    ds_read_b64_tr_b16 v[148:149], v7 offset:36864
    ds_read_b64_tr_b16 v[150:151], v7 offset:37376
    v_mfma_f32_16x16x32_bf16 v[100:103], v[40:43], v[116:119], v[100:103]
    v_mfma_f32_16x16x32_bf16 v[104:107], v[40:43], v[120:123], v[104:107]
    v_mfma_f32_16x16x32_bf16 v[108:111], v[40:43], v[124:127], v[108:111]
    s_waitcnt lgkmcnt(7)
    s_nop 0
    v_mfma_f32_32x32x16_bf16 v[64:79], v[136:139], v[128:131], v[64:79]
    ds_read_b128 v[160:163], v5 offset:32768
    ds_read_b64_tr_b16 v[168:169], v7 offset:47104
    ds_read_b64_tr_b16 v[170:171], v7 offset:47616
    v_mfma_f32_32x32x16_bf16 v[80:95], v[128:131], v[140:143], v[80:95]
    ds_read_b64_tr_b16 v[172:173], v7 offset:55296
    ds_read_b64_tr_b16 v[174:175], v7 offset:55808
    v_mfma_f32_32x32x16_bf16 v[48:63], v[132:135], v[128:131], v[48:63]
    ds_read_b64_tr_b16 v[164:165], v7 offset:38912
    ds_read_b64_tr_b16 v[166:167], v7 offset:39424
    v_mfma_f32_16x16x32_bf16 v[100:103], v[40:43], v[132:135], v[100:103]
    v_mfma_f32_16x16x32_bf16 v[104:107], v[40:43], v[136:139], v[104:107]
    v_mfma_f32_16x16x32_bf16 v[108:111], v[40:43], v[140:143], v[108:111]
    s_add_u32 s46, s46, 1
    s_cmp_eq_u32 s46, 4
    s_cbranch_scc1 L_clast
    s_nop 0
    v_xor_b32 v2, 0x10000, v2
    v_xor_b32 v3, 0x10000, v3
    v_xor_b32 v4, 0x10000, v4
    v_xor_b32 v5, 0x10000, v5
    v_xor_b32 v6, 0x10000, v6
    v_xor_b32 v7, 0x10000, v7
    s_waitcnt lgkmcnt(7)
    s_barrier
    v_mfma_f32_32x32x16_bf16 v[64:79], v[152:155], v[144:147], v[64:79]
    ds_read_b128 v[112:115], v2 offset:0
    ds_read_b64_tr_b16 v[120:121], v6 offset:8192
    ds_read_b64_tr_b16 v[122:123], v6 offset:8704
    v_mfma_f32_32x32x16_bf16 v[80:95], v[144:147], v[156:159], v[80:95]
    ds_read_b64_tr_b16 v[124:125], v6 offset:16384
    ds_read_b64_tr_b16 v[126:127], v6 offset:16896
    v_mfma_f32_32x32x16_bf16 v[48:63], v[148:151], v[144:147], v[48:63]
    ds_read_b64_tr_b16 v[116:117], v6 offset:0
    ds_read_b64_tr_b16 v[118:119], v6 offset:512
    s_waitcnt lgkmcnt(7)
    s_nop 0
    v_mfma_f32_32x32x16_bf16 v[64:79], v[168:171], v[160:163], v[64:79]
    ds_read_b128 v[128:131], v3 offset:0
    ds_read_b64_tr_b16 v[136:137], v6 offset:10240
    ds_read_b64_tr_b16 v[138:139], v6 offset:10752
    v_mfma_f32_32x32x16_bf16 v[80:95], v[160:163], v[172:175], v[80:95]
    ds_read_b64_tr_b16 v[140:141], v6 offset:18432
    ds_read_b64_tr_b16 v[142:143], v6 offset:18944
    v_mfma_f32_32x32x16_bf16 v[48:63], v[164:167], v[160:163], v[48:63]
    ds_read_b64_tr_b16 v[132:133], v6 offset:2048
    ds_read_b64_tr_b16 v[134:135], v6 offset:2560
    s_branch L_cloop
L_clast:
    s_setprio 2
    s_mul_i32 s3, s44, 384
    s_add_u32 s3, s3, 155648
    v_lshl_add_u32 v1, v0, 2, s3
    s_waitcnt lgkmcnt(7)
    s_nop 0
    v_mfma_f32_32x32x16_bf16 v[64:79], v[152:155], v[144:147], v[64:79]
    v_mfma_f32_32x32x16_bf16 v[80:95], v[144:147], v[156:159], v[80:95]
    v_mfma_f32_32x32x16_bf16 v[48:63], v[148:151], v[144:147], v[48:63]
    s_mov_b64 exec, 0xffff
    ds_add_f32 v1, v100 offset:0
    ds_add_f32 v1, v101 offset:64
    ds_add_f32 v1, v104 offset:128
    ds_add_f32 v1, v105 offset:192
    ds_add_f32 v1, v108 offset:256
    ds_add_f32 v1, v109 offset:320
    s_mov_b64 exec, -1
    s_waitcnt lgkmcnt(6)
    v_mfma_f32_32x32x16_bf16 v[64:79], v[168:171], v[160:163], v[64:79]
    v_mfma_f32_32x32x16_bf16 v[80:95], v[160:163], v[172:175], v[80:95]
    v_mfma_f32_32x32x16_bf16 v[48:63], v[164:167], v[160:163], v[48:63]
    s_waitcnt lgkmcnt(0)
    s_barrier
    v_lshrrev_b32 v8, 5, v0
    v_lshlrev_b32 v8, 4, v8
    s_mul_i32 s3, s44, 384
    s_add_u32 s3, s3, 155648
    s_mov_b32 s55, s3
    v_add_u32_e64 v1, s3, v8
    s_lshl_b32 s47, s43, 7
    s_add_u32 s47, s47, 156672
    v_add_u32 v8, s47, v8
    v_and_b32 v9, 31, v0
    v_lshl_add_u32 v10, v9, 2, s47
    v_lshl_add_u32 v9, v9, 2, s3
    ds_read_b128 v[128:131], v1 offset:128
    ds_read_b128 v[132:135], v1 offset:160
    ds_read_b128 v[136:139], v1 offset:192
    ds_read_b128 v[140:143], v1 offset:224
    ds_read_b32 v18, v10
    ds_read_b32 v12, v10 offset:256
    ds_read_b32 v14, v9 offset:256
    ds_read_b128 v[144:147], v8 offset:0
    ds_read_b128 v[160:163], v8 offset:256
    ds_read_b128 v[148:151], v8 offset:32
    ds_read_b128 v[164:167], v8 offset:288
    ds_read_b128 v[152:155], v8 offset:64
    ds_read_b128 v[168:171], v8 offset:320
    ds_read_b128 v[156:159], v8 offset:96
    ds_read_b128 v[172:175], v8 offset:352
    s_lshl_b32 s47, s39, 1
    s_add_u32 s47, s47, s43
    s_lshl_b32 s47, s47, 5
    s_lshl_b32 s48, s40, 2
    s_add_u32 s47, s47, s48
    s_lshl_b32 s48, s44, 1
    s_add_u32 s47, s47, s48
    s_lshl_b32 s47, s47, 10
    s_add_u32 s49, s47, 0x400000
    s_add_u32 s50, s47, 0x600000
    s_lshl_b32 s51, s43, 13
    s_lshl_b32 s52, s44, 12
    s_add_u32 s51, s51, s52
    s_add_u32 s51, s51, 131072
    s_lshl_b32 s52, s43, 2
    s_lshl_b32 s53, s44, 1
    s_add_u32 s52, s52, s53
    s_lshl_b32 s52, s52, 10
    s_add_u32 s52, s52, 147456
    v_lshlrev_b32 v9, 4, v0
    v_add_u32 v15, s51, v9
    v_add_u32 v16, s52, v9
    v_bfe_u32 v1, v0, 4, 1
    v_lshlrev_b32 v10, 10, v1
    v_lshrrev_b32 v8, 5, v0
    v_lshl_add_u32 v10, v8, 8, v10
    v_and_b32_e64 v8, 15, v0
    v_lshl_add_u32 v10, v8, 4, v10
    v_lshl_add_u32 v17, v1, 10, v10
    v_add_u32 v17, s51, v17
    s_waitcnt lgkmcnt(8)
    v_pk_fma_f32 v[64:65], v[18:19], v[128:129], v[64:65] op_sel_hi:[0,1,1] neg_lo:[1,0,0] neg_hi:[1,0,0]
    v_pk_fma_f32 v[66:67], v[18:19], v[130:131], v[66:67] op_sel_hi:[0,1,1] neg_lo:[1,0,0] neg_hi:[1,0,0]
    v_pk_fma_f32 v[68:69], v[18:19], v[132:133], v[68:69] op_sel_hi:[0,1,1] neg_lo:[1,0,0] neg_hi:[1,0,0]
    v_pk_fma_f32 v[70:71], v[18:19], v[134:135], v[70:71] op_sel_hi:[0,1,1] neg_lo:[1,0,0] neg_hi:[1,0,0]
    v_pk_fma_f32 v[72:73], v[18:19], v[136:137], v[72:73] op_sel_hi:[0,1,1] neg_lo:[1,0,0] neg_hi:[1,0,0]
    v_pk_fma_f32 v[74:75], v[18:19], v[138:139], v[74:75] op_sel_hi:[0,1,1] neg_lo:[1,0,0] neg_hi:[1,0,0]
    v_pk_fma_f32 v[76:77], v[18:19], v[140:141], v[76:77] op_sel_hi:[0,1,1] neg_lo:[1,0,0] neg_hi:[1,0,0]
    v_pk_fma_f32 v[78:79], v[18:19], v[142:143], v[78:79] op_sel_hi:[0,1,1] neg_lo:[1,0,0] neg_hi:[1,0,0]
    v_pk_mul_f32 v[64:65], v[12:13], v[64:65] op_sel_hi:[0,1]
    v_pk_mul_f32 v[66:67], v[12:13], v[66:67] op_sel_hi:[0,1]
    v_pk_mul_f32 v[68:69], v[12:13], v[68:69] op_sel_hi:[0,1]
    v_pk_mul_f32 v[70:71], v[12:13], v[70:71] op_sel_hi:[0,1]
    v_pk_mul_f32 v[72:73], v[12:13], v[72:73] op_sel_hi:[0,1]
    v_pk_mul_f32 v[74:75], v[12:13], v[74:75] op_sel_hi:[0,1]
    v_pk_mul_f32 v[76:77], v[12:13], v[76:77] op_sel_hi:[0,1]
    v_pk_mul_f32 v[78:79], v[12:13], v[78:79] op_sel_hi:[0,1]
    v_cvt_pk_bf16_f32 v20, v64, v65
    v_cvt_pk_bf16_f32 v21, v66, v67
    v_cvt_pk_bf16_f32 v22, v68, v69
    v_cvt_pk_bf16_f32 v23, v70, v71
    buffer_store_dwordx4 v[20:23], v9, s[12:15], s49 offen offset:0 sc1
    v_cvt_pk_bf16_f32 v24, v72, v73
    v_cvt_pk_bf16_f32 v25, v74, v75
    v_cvt_pk_bf16_f32 v26, v76, v77
    v_cvt_pk_bf16_f32 v27, v78, v79
    buffer_store_dwordx4 v[24:27], v9, s[12:15], s49 offen offset:1024 sc1
    s_waitcnt lgkmcnt(0)
    v_lshrrev_b32 v8, 5, v0
    v_lshl_add_u32 v8, v8, 4, s55
    v_pk_fma_f32 v[80:81], v[144:145], v[14:15], v[80:81] op_sel_hi:[1,0,1] neg_lo:[1,0,0] neg_hi:[1,0,0]
    v_pk_fma_f32 v[82:83], v[146:147], v[14:15], v[82:83] op_sel_hi:[1,0,1] neg_lo:[1,0,0] neg_hi:[1,0,0]
    v_pk_fma_f32 v[84:85], v[148:149], v[14:15], v[84:85] op_sel_hi:[1,0,1] neg_lo:[1,0,0] neg_hi:[1,0,0]
    v_pk_fma_f32 v[86:87], v[150:151], v[14:15], v[86:87] op_sel_hi:[1,0,1] neg_lo:[1,0,0] neg_hi:[1,0,0]
    v_pk_fma_f32 v[88:89], v[152:153], v[14:15], v[88:89] op_sel_hi:[1,0,1] neg_lo:[1,0,0] neg_hi:[1,0,0]
    v_pk_fma_f32 v[90:91], v[154:155], v[14:15], v[90:91] op_sel_hi:[1,0,1] neg_lo:[1,0,0] neg_hi:[1,0,0]
    v_pk_fma_f32 v[92:93], v[156:157], v[14:15], v[92:93] op_sel_hi:[1,0,1] neg_lo:[1,0,0] neg_hi:[1,0,0]
    v_pk_fma_f32 v[94:95], v[158:159], v[14:15], v[94:95] op_sel_hi:[1,0,1] neg_lo:[1,0,0] neg_hi:[1,0,0]
    v_pk_mul_f32 v[80:81], v[160:161], v[80:81]
    v_pk_mul_f32 v[82:83], v[162:163], v[82:83]
    v_pk_mul_f32 v[84:85], v[164:165], v[84:85]
    v_pk_mul_f32 v[86:87], v[166:167], v[86:87]
    v_pk_mul_f32 v[88:89], v[168:169], v[88:89]
    v_pk_mul_f32 v[90:91], v[170:171], v[90:91]
    v_pk_mul_f32 v[92:93], v[172:173], v[92:93]
    v_pk_mul_f32 v[94:95], v[174:175], v[94:95]
    ds_read_b128 v[112:115], v8 offset:0
    ds_read_b128 v[116:119], v8 offset:32
    ds_read_b128 v[120:123], v8 offset:64
    ds_read_b128 v[124:127], v8 offset:96
    v_cvt_pk_bf16_f32 v28, v80, v81
    v_cvt_pk_bf16_f32 v29, v82, v83
    v_cvt_pk_bf16_f32 v30, v84, v85
    v_cvt_pk_bf16_f32 v31, v86, v87
    buffer_store_dwordx4 v[28:31], v10, s[12:15], s50 offen offset:0 sc1
    v_cvt_pk_bf16_f32 v32, v88, v89
    v_cvt_pk_bf16_f32 v33, v90, v91
    v_cvt_pk_bf16_f32 v34, v92, v93
    v_cvt_pk_bf16_f32 v35, v94, v95
    buffer_store_dwordx4 v[32:35], v10, s[12:15], s50 offen offset:512 sc1
    ds_write_b128 v15, v[20:23] offset:0
    ds_write_b128 v15, v[24:27] offset:2048
    ds_write_b128 v17, v[28:31] offset:1024
    ds_write_b128 v17, v[32:35] offset:1536
    v_mul_f32 v196, 0x3eb8aa3b, v12
    s_waitcnt lgkmcnt(4)
    s_nop 0
    v_pk_fma_f32 v[48:49], v[18:19], v[112:113], v[48:49] op_sel_hi:[0,1,1] neg_lo:[1,0,0] neg_hi:[1,0,0]
    v_pk_fma_f32 v[50:51], v[18:19], v[114:115], v[50:51] op_sel_hi:[0,1,1] neg_lo:[1,0,0] neg_hi:[1,0,0]
    v_pk_fma_f32 v[52:53], v[18:19], v[116:117], v[52:53] op_sel_hi:[0,1,1] neg_lo:[1,0,0] neg_hi:[1,0,0]
    v_pk_fma_f32 v[54:55], v[18:19], v[118:119], v[54:55] op_sel_hi:[0,1,1] neg_lo:[1,0,0] neg_hi:[1,0,0]
    v_pk_fma_f32 v[56:57], v[18:19], v[120:121], v[56:57] op_sel_hi:[0,1,1] neg_lo:[1,0,0] neg_hi:[1,0,0]
    v_pk_fma_f32 v[58:59], v[18:19], v[122:123], v[58:59] op_sel_hi:[0,1,1] neg_lo:[1,0,0] neg_hi:[1,0,0]
    v_pk_fma_f32 v[60:61], v[18:19], v[124:125], v[60:61] op_sel_hi:[0,1,1] neg_lo:[1,0,0] neg_hi:[1,0,0]
    v_pk_fma_f32 v[62:63], v[18:19], v[126:127], v[62:63] op_sel_hi:[0,1,1] neg_lo:[1,0,0] neg_hi:[1,0,0]
    v_pk_mul_f32 v[48:49], v[196:197], v[48:49] op_sel_hi:[0,1]
    v_pk_mul_f32 v[50:51], v[196:197], v[50:51] op_sel_hi:[0,1]
    v_pk_mul_f32 v[52:53], v[196:197], v[52:53] op_sel_hi:[0,1]
    v_pk_mul_f32 v[54:55], v[196:197], v[54:55] op_sel_hi:[0,1]
    v_pk_mul_f32 v[56:57], v[196:197], v[56:57] op_sel_hi:[0,1]
    v_pk_mul_f32 v[58:59], v[196:197], v[58:59] op_sel_hi:[0,1]
    v_pk_mul_f32 v[60:61], v[196:197], v[60:61] op_sel_hi:[0,1]
    v_pk_mul_f32 v[62:63], v[196:197], v[62:63] op_sel_hi:[0,1]
    v_cvt_pk_bf16_f32 v36, v48, v49
    v_cvt_pk_bf16_f32 v37, v50, v51
    v_cvt_pk_bf16_f32 v38, v52, v53
    v_cvt_pk_bf16_f32 v39, v54, v55
    ds_write_b128 v16, v[36:39] offset:0
    v_cvt_pk_bf16_f32 v40, v56, v57
    v_cvt_pk_bf16_f32 v41, v58, v59
    v_cvt_pk_bf16_f32 v42, v60, v61
    v_cvt_pk_bf16_f32 v43, v62, v63
    ds_write_b128 v16, v[40:43] offset:1024
    v_mov_b32 v1, 157184
    v_mov_b32_e64 v2, 1
    s_waitcnt vmcnt(0)
    s_mov_b64 exec, 1
    ds_add_rtn_u32 v3, v1, v2
    s_waitcnt lgkmcnt(0)
    v_readfirstlane_b32 s3, v3
    s_mov_b64 exec, -1
    s_nop 0
    s_cmp_lg_u32 s3, 3
    s_cbranch_scc1 L_cjoin
    s_lshl_b32 s3, s39, 3
    s_add_u32 s3, s3, s40
    s_lshl_b32 s3, s3, 7
    s_add_u32 s3, s3, 0xa10000
    v_mov_b32 v2, s3
    v_mov_b32 v3, s41
    s_mov_b64 exec, 1
    buffer_store_dword v3, v2, s[12:15], 0 offen sc1
    s_mov_b64 exec, -1
L_cjoin:
    s_lshl_b32 s54, s39, 3
    s_add_u32 s54, s54, s40
    s_cmp_lt_u32 s54, 28
    s_cbranch_scc1 L_cffn
    s_setprio 0
    s_branch L_pre_att
L_cffn:
    s_waitcnt lgkmcnt(0)
    s_mov_b32 s68, s38
    s_mov_b32 s69, 1
    s_cmp_ge_u32 s39, 1
    s_cselect_b32 s93, 1, 0
    s_branch L_setup
L_pre_att:
    s_lshl_b32 s3, s38, 6
    v_add_u32 v208, s3, v0
    v_lshrrev_b32 v1, 3, v208
    s_lshl_b32 s3, s39, 6
    v_add_u32 v1, s3, v1
    v_lshlrev_b32 v1, 10, v1
    v_and_b32 v2, 7, v208
    v_lshl_add_u32 v1, v2, 4, v1
    s_lshl_b32 s3, s40, 7
    v_add_u32 v209, s3, v1
    buffer_load_dwordx4 v[200:203], v209, s[4:7], 0 offen
    s_mov_b32 s68, s38
    s_mov_b32 s69, 0
    s_mov_b32 s93, 1
L_setup:
    s_mov_b32 s46, 0x0000ffff
    s_mov_b32 s47, 0x0000ffff
    v_and_b32 v1, 31, v0
    v_lshrrev_b32 v2, 5, v0
    v_lshlrev_b32 v2, 2, v2
    v_sub_u32_e64 v1, v1, v2
    v_mov_b32 v2, 0xf149f2ca
    v_mov_b32_e64 v3, 0
    v_cmp_le_i32 s[48:49], 0, v1
    s_nop 1
    v_cndmask_b32 v96, v2, v3, s[48:49]
    v_cndmask_b32 v112, v3, v2, s[48:49]
    v_cmp_le_i32 s[48:49], 1, v1
    s_nop 1
    v_cndmask_b32 v97, v2, v3, s[48:49]
    v_cndmask_b32 v113, v3, v2, s[48:49]
    v_cmp_le_i32 s[48:49], 2, v1
    s_nop 1
    v_cndmask_b32 v98, v2, v3, s[48:49]
    v_cndmask_b32 v114, v3, v2, s[48:49]
    v_cmp_le_i32 s[48:49], 3, v1
    s_nop 1
    v_cndmask_b32 v99, v2, v3, s[48:49]
    v_cndmask_b32 v115, v3, v2, s[48:49]
    v_cmp_le_i32 s[48:49], 8, v1
    s_nop 1
    v_cndmask_b32 v100, v2, v3, s[48:49]
    v_cndmask_b32 v116, v3, v2, s[48:49]
    v_cmp_le_i32 s[48:49], 9, v1
    s_nop 1
    v_cndmask_b32 v101, v2, v3, s[48:49]
    v_cndmask_b32 v117, v3, v2, s[48:49]
    v_cmp_le_i32 s[48:49], 10, v1
    s_nop 1
    v_cndmask_b32 v102, v2, v3, s[48:49]
    v_cndmask_b32 v118, v3, v2, s[48:49]
    v_cmp_le_i32 s[48:49], 11, v1
    s_nop 1
    v_cndmask_b32 v103, v2, v3, s[48:49]
    v_cndmask_b32 v119, v3, v2, s[48:49]
    v_cmp_le_i32 s[48:49], 16, v1
    s_nop 1
    v_cndmask_b32 v104, v2, v3, s[48:49]
    v_cndmask_b32 v120, v3, v2, s[48:49]
    v_cmp_le_i32 s[48:49], 17, v1
    s_nop 1
    v_cndmask_b32 v105, v2, v3, s[48:49]
    v_cndmask_b32 v121, v3, v2, s[48:49]
    v_cmp_le_i32 s[48:49], 18, v1
    s_nop 1
    v_cndmask_b32 v106, v2, v3, s[48:49]
    v_cndmask_b32 v122, v3, v2, s[48:49]
    v_cmp_le_i32 s[48:49], 19, v1
    s_nop 1
    v_cndmask_b32 v107, v2, v3, s[48:49]
    v_cndmask_b32 v123, v3, v2, s[48:49]
    v_cmp_le_i32 s[48:49], 24, v1
    s_nop 1
    v_cndmask_b32 v108, v2, v3, s[48:49]
    v_cndmask_b32 v124, v3, v2, s[48:49]
    v_cmp_le_i32 s[48:49], 25, v1
    s_nop 1
    v_cndmask_b32 v109, v2, v3, s[48:49]
    v_cndmask_b32 v125, v3, v2, s[48:49]
    v_cmp_le_i32 s[48:49], 26, v1
    s_nop 1
    v_cndmask_b32 v110, v2, v3, s[48:49]
    v_cndmask_b32 v126, v3, v2, s[48:49]
    v_cmp_le_i32 s[48:49], 27, v1
    s_nop 1
    v_cndmask_b32 v111, v2, v3, s[48:49]
    v_cndmask_b32 v127, v3, v2, s[48:49]
    v_mov_b32 v24, 0x3f803f80
    v_mov_b32 v25, 0x3f803f80
    v_mov_b32 v26, 0x3f803f80
    v_mov_b32 v27, 0x3f803f80
    v_mov_b32 v28, 0x3f803f80
    v_mov_b32 v29, 0x3f803f80
    v_mov_b32 v30, 0x3f803f80
    v_mov_b32 v31, 0x3f803f80
    v_mov_b32 v32, 0x3f803f80
    v_mov_b32 v33, 0x3f803f80
    v_mov_b32 v34, 0x3f803f80
    v_mov_b32 v35, 0x3f803f80
    v_mov_b32 v36, 0x3f803f80
    v_mov_b32 v37, 0x3f803f80
    v_mov_b32 v38, 0x3f803f80
    v_mov_b32 v39, 0x3f803f80
L_setup2:
    s_and_b32 s43, s68, 1
    s_lshr_b32 s44, s68, 1
    s_lshl_b32 s45, s39, 1
    s_add_u32 s45, s45, s43
    s_lshl_b32 s3, s43, 13
    s_lshl_b32 s48, s44, 11
    s_add_u32 s3, s3, s48
    s_add_u32 s3, s3, 65536
    v_lshl_add_u32 v12, v0, 4, s3
    v_add_u32 v13, 0x8000, v12
    v_lshrrev_b32 v1, 5, v0
    v_lshlrev_b32 v1, 8, v1
    v_and_b32 v2, 15, v0
    v_lshl_add_u32 v1, v2, 4, v1
    v_add_u32_e64 v1, s3, v1
    v_add_u32 v14, 0x400, v1
    v_add_u32 v15, 0x8000, v14
    s_lshl_b32 s3, s43, 2
    s_add_u32 s3, s3, s44
    s_lshl_b32 s3, s3, 10
    s_add_u32 s3, s3, 147456
    v_lshl_add_u32 v8, v0, 4, s3
    v_lshrrev_b32 v128, 3, v0
    s_lshl_b32 s3, s68, 6
    v_add_u32 v128, s3, v128
    v_lshlrev_b32 v128, 10, v128
    s_lshl_b32 s3, s40, 7
    v_add_u32_e64 v128, s3, v128
    v_bfe_u32 v1, v0, 4, 1
    v_lshlrev_b32 v1, 2, v1
    v_and_b32 v2, 7, v0
    v_xor_b32_e64 v1, v1, v2
    v_lshl_add_u32 v128, v1, 4, v128
    s_lshl_b32 s55, s68, 13
    v_mov_b32 v80, 0
    v_mov_b32 v81, 0
    v_mov_b32 v82, 0
    v_mov_b32 v83, 0
    v_mov_b32 v84, 0
    v_mov_b32 v85, 0
    v_mov_b32 v86, 0
    v_mov_b32 v87, 0
    v_mov_b32 v88, 0
    v_mov_b32 v89, 0
    v_mov_b32 v90, 0
    v_mov_b32 v91, 0
    v_mov_b32 v92, 0
    v_mov_b32 v93, 0
    v_mov_b32 v94, 0
    v_mov_b32 v95, 0
    s_cmp_eq_u32 s69, 3
    s_cbranch_scc1 L_body
    s_cmp_eq_u32 s69, 1
    s_cbranch_scc1 L_csync
    s_waitcnt vmcnt(0) lgkmcnt(0)
    s_barrier
L_bz:
    v_lshrrev_b32 v1, 3, v208
    v_lshlrev_b32_e64 v1, 2, v1
    v_add_u32 v1, 156672, v1
    ds_read_b32 v210, v1
    ds_read_b32 v211, v1 offset:256
L_body:
    ds_read_b128 v[4:7], v8
    s_cmp_eq_u32 s45, 0
    s_cbranch_scc1 L_att_stub8
    s_cmp_eq_u32 s45, 1
    s_cbranch_scc1 L_att_stub7
    s_cmp_eq_u32 s45, 2
    s_cbranch_scc1 L_att_stub6
    s_cmp_eq_u32 s45, 3
    s_cbranch_scc1 L_att_stub5
    s_cmp_eq_u32 s45, 4
    s_cbranch_scc1 L_att_stub4
    s_cmp_eq_u32 s45, 5
    s_cbranch_scc1 L_att_stub3
    s_cmp_eq_u32 s45, 6
    s_cbranch_scc1 L_att_stub2
    s_cmp_eq_u32 s45, 7
    s_cbranch_scc1 L_att_stub1
L_att_stub0:
    ds_read_b128 v[16:19], v12 offset:0
    s_mov_b64 exec, s[46:47]
    ds_read_b128 v[24:27], v14 offset:0
    ds_read_b128 v[28:31], v14 offset:512
    s_mov_b64 exec, -1
    s_waitcnt lgkmcnt(2)
    v_mfma_f32_32x32x16_bf16 v[48:63], v[16:19], v[4:7], v[112:127]
    ds_read_b128 v[20:23], v12 offset:8192
L_att_step0:
    s_nop 10
    v_exp_f32 v48, v48
    v_exp_f32 v49, v49
    v_exp_f32 v50, v50
    v_exp_f32 v51, v51
    v_cvt_pk_bf16_f32 v40, v48, v49
    v_cvt_pk_bf16_f32 v41, v50, v51
    s_waitcnt lgkmcnt(0)
    v_mfma_f32_32x32x16_bf16 v[64:79], v[20:23], v[4:7], 0
    v_exp_f32 v52, v52
    v_exp_f32 v53, v53
    v_exp_f32 v54, v54
    v_exp_f32_e64 v55, v55
    v_cvt_pk_bf16_f32 v42, v52, v53
    v_cvt_pk_bf16_f32 v43, v54, v55
    ds_read_b128 v[16:19], v12 offset:16384
    v_exp_f32 v56, v56
    v_exp_f32 v57, v57
    v_mfma_f32_32x32x16_bf16 v[80:95], v[24:27], v[40:43], v[80:95]
    v_exp_f32 v58, v58
    v_exp_f32 v59, v59
    v_exp_f32 v60, v60
    v_exp_f32 v61, v61
    v_cvt_pk_bf16_f32 v44, v56, v57
    v_cvt_pk_bf16_f32 v45, v58, v59
    v_exp_f32 v62, v62
    v_exp_f32 v63, v63
    v_cvt_pk_bf16_f32 v46, v60, v61
    v_cvt_pk_bf16_f32 v47, v62, v63
    s_nop 1
    v_mfma_f32_32x32x16_bf16 v[80:95], v[28:31], v[44:47], v[80:95]
    s_mov_b64 exec, s[46:47]
    ds_read_b128 v[32:35], v14 offset:8192
    ds_read_b128 v[36:39], v14 offset:8704
    s_mov_b64 exec, -1
L_att_step1:
    s_nop 1
    v_exp_f32 v64, v64
    v_exp_f32 v65, v65
    v_exp_f32 v66, v66
    v_exp_f32 v67, v67
    v_cvt_pk_bf16_f32 v40, v64, v65
    v_cvt_pk_bf16_f32 v41, v66, v67
    s_waitcnt lgkmcnt(0)
    v_mfma_f32_32x32x16_bf16 v[48:63], v[16:19], v[4:7], 0
    v_exp_f32 v68, v68
    v_exp_f32 v69, v69
    v_exp_f32 v70, v70
    v_exp_f32_e64 v71, v71
    v_cvt_pk_bf16_f32 v42, v68, v69
    v_cvt_pk_bf16_f32 v43, v70, v71
    ds_read_b128 v[20:23], v12 offset:24576
    v_exp_f32 v72, v72
    v_exp_f32 v73, v73
    v_mfma_f32_32x32x16_bf16 v[80:95], v[32:35], v[40:43], v[80:95]
    v_exp_f32 v74, v74
    v_exp_f32 v75, v75
    v_exp_f32 v76, v76
    v_exp_f32 v77, v77
    s_cmp_eq_u32 s93, 0
    s_cbranch_scc1 L29_nwo
    s_add_u32 m0, s55, 0
    s_mov_b32 s56, 0
    buffer_load_dwordx4 v128, s[16:19], s56 offen lds
L29_nwo:
    v_cvt_pk_bf16_f32 v44, v72, v73
    v_cvt_pk_bf16_f32 v45, v74, v75
    v_exp_f32 v78, v78
    v_exp_f32 v79, v79
    v_cvt_pk_bf16_f32 v46, v76, v77
    v_cvt_pk_bf16_f32 v47, v78, v79
    s_nop 1
    v_mfma_f32_32x32x16_bf16 v[80:95], v[36:39], v[44:47], v[80:95]
    s_mov_b64 exec, s[46:47]
    ds_read_b128 v[24:27], v14 offset:16384
    ds_read_b128 v[28:31], v14 offset:16896
    s_mov_b64 exec, -1
L_att_step2:
    v_exp_f32 v48, v48
    v_exp_f32 v49, v49
    v_exp_f32 v50, v50
    v_exp_f32_e64 v51, v51
    v_cvt_pk_bf16_f32 v40, v48, v49
    v_cvt_pk_bf16_f32 v41, v50, v51
    s_waitcnt lgkmcnt(0)
    v_mfma_f32_32x32x16_bf16 v[64:79], v[20:23], v[4:7], 0
    v_exp_f32 v52, v52
    v_exp_f32 v53, v53
    v_exp_f32 v54, v54
    v_exp_f32_e64 v55, v55
    v_cvt_pk_bf16_f32 v42, v52, v53
    v_cvt_pk_bf16_f32 v43, v54, v55
    ds_read_b128 v[16:19], v13 offset:0
    v_exp_f32 v56, v56
    v_exp_f32 v57, v57
    v_mfma_f32_32x32x16_bf16 v[80:95], v[24:27], v[40:43], v[80:95]
    v_exp_f32 v58, v58
    v_exp_f32 v59, v59
    v_exp_f32 v60, v60
    v_exp_f32 v61, v61
    s_cmp_eq_u32 s93, 0
    s_cbranch_scc1 L30_nwo
    s_add_u32 m0, s55, 1024
    s_mov_b32 s56, 8192
    buffer_load_dwordx4 v128, s[16:19], s56 offen lds
L30_nwo:
    v_cvt_pk_bf16_f32 v44, v56, v57
    v_cvt_pk_bf16_f32 v45, v58, v59
    v_exp_f32 v62, v62
    v_exp_f32 v63, v63
    v_cvt_pk_bf16_f32 v46, v60, v61
    v_cvt_pk_bf16_f32 v47, v62, v63
    s_nop 1
    v_mfma_f32_32x32x16_bf16 v[80:95], v[28:31], v[44:47], v[80:95]
    s_mov_b64 exec, s[46:47]
    ds_read_b128 v[32:35], v14 offset:24576
    ds_read_b128 v[36:39], v14 offset:25088
    s_mov_b64 exec, -1
L_att_step3:
    v_exp_f32 v64, v64
    v_exp_f32 v65, v65
    v_exp_f32 v66, v66
    v_exp_f32_e64 v67, v67
    v_cvt_pk_bf16_f32 v40, v64, v65
    v_cvt_pk_bf16_f32 v41, v66, v67
    s_waitcnt lgkmcnt(0)
    v_mfma_f32_32x32x16_bf16 v[48:63], v[16:19], v[4:7], 0
    v_exp_f32 v68, v68
    v_exp_f32 v69, v69
    v_exp_f32 v70, v70
    v_exp_f32_e64 v71, v71
    v_cvt_pk_bf16_f32 v42, v68, v69
    v_cvt_pk_bf16_f32 v43, v70, v71
    ds_read_b128 v[20:23], v13 offset:8192
    v_exp_f32 v72, v72
    v_exp_f32 v73, v73
    v_mfma_f32_32x32x16_bf16 v[80:95], v[32:35], v[40:43], v[80:95]
    v_exp_f32 v74, v74
    v_exp_f32 v75, v75
    v_exp_f32 v76, v76
    v_exp_f32 v77, v77
    s_cmp_eq_u32 s93, 0
    s_cbranch_scc1 L31_nwo
    s_add_u32 m0, s55, 2048
    s_mov_b32 s56, 16384
    buffer_load_dwordx4 v128, s[16:19], s56 offen lds
L31_nwo:
    v_cvt_pk_bf16_f32 v44, v72, v73
    v_cvt_pk_bf16_f32 v45, v74, v75
    v_exp_f32 v78, v78
    v_exp_f32 v79, v79
    v_cvt_pk_bf16_f32 v46, v76, v77
    v_cvt_pk_bf16_f32 v47, v78, v79
    s_nop 1
    v_mfma_f32_32x32x16_bf16 v[80:95], v[36:39], v[44:47], v[80:95]
    s_mov_b64 exec, s[46:47]
    ds_read_b128 v[24:27], v15 offset:0
    ds_read_b128 v[28:31], v15 offset:512
    s_mov_b64 exec, -1
L_att_step4:
    v_exp_f32 v48, v48
    v_exp_f32 v49, v49
    v_exp_f32 v50, v50
    v_exp_f32_e64 v51, v51
    v_cvt_pk_bf16_f32 v40, v48, v49
    v_cvt_pk_bf16_f32 v41, v50, v51
    s_waitcnt lgkmcnt(0)
    v_mfma_f32_32x32x16_bf16 v[64:79], v[20:23], v[4:7], 0
    v_exp_f32 v52, v52
    v_exp_f32 v53, v53
    v_exp_f32 v54, v54
    v_exp_f32_e64 v55, v55
    v_cvt_pk_bf16_f32 v42, v52, v53
    v_cvt_pk_bf16_f32 v43, v54, v55
    ds_read_b128 v[16:19], v13 offset:16384
    v_exp_f32 v56, v56
    v_exp_f32 v57, v57
    v_mfma_f32_32x32x16_bf16 v[80:95], v[24:27], v[40:43], v[80:95]
    v_exp_f32 v58, v58
    v_exp_f32 v59, v59
    v_exp_f32 v60, v60
    v_exp_f32 v61, v61
    s_cmp_eq_u32 s93, 0
    s_cbranch_scc1 L32_nwo
    s_add_u32 m0, s55, 3072
    s_mov_b32 s56, 24576
    buffer_load_dwordx4 v128, s[16:19], s56 offen lds
L32_nwo:
    v_cvt_pk_bf16_f32 v44, v56, v57
    v_cvt_pk_bf16_f32 v45, v58, v59
    v_exp_f32 v62, v62
    v_exp_f32 v63, v63
    v_cvt_pk_bf16_f32 v46, v60, v61
    v_cvt_pk_bf16_f32 v47, v62, v63
    s_nop 1
    v_mfma_f32_32x32x16_bf16 v[80:95], v[28:31], v[44:47], v[80:95]
    s_mov_b64 exec, s[46:47]
    ds_read_b128 v[32:35], v15 offset:8192
    ds_read_b128 v[36:39], v15 offset:8704
    s_mov_b64 exec, -1
L_att_step5:
    v_exp_f32 v64, v64
    v_exp_f32 v65, v65
    v_exp_f32 v66, v66
    v_exp_f32_e64 v67, v67
    v_cvt_pk_bf16_f32 v40, v64, v65
    v_cvt_pk_bf16_f32 v41, v66, v67
    s_waitcnt lgkmcnt(0)
    v_mfma_f32_32x32x16_bf16 v[48:63], v[16:19], v[4:7], 0
    v_exp_f32 v68, v68
    v_exp_f32 v69, v69
    v_exp_f32 v70, v70
    v_exp_f32_e64 v71, v71
    v_cvt_pk_bf16_f32 v42, v68, v69
    v_cvt_pk_bf16_f32 v43, v70, v71
    ds_read_b128 v[20:23], v13 offset:24576
    v_exp_f32 v72, v72
    v_exp_f32 v73, v73
    v_mfma_f32_32x32x16_bf16 v[80:95], v[32:35], v[40:43], v[80:95]
    v_exp_f32 v74, v74
    v_exp_f32 v75, v75
    v_exp_f32 v76, v76
    v_exp_f32 v77, v77
    s_cmp_eq_u32 s93, 0
    s_cbranch_scc1 L33_nwo
    s_add_u32 m0, s55, 4096
    s_mov_b32 s56, 32768
    buffer_load_dwordx4 v128, s[16:19], s56 offen lds
L33_nwo:
    v_cvt_pk_bf16_f32 v44, v72, v73
    v_cvt_pk_bf16_f32 v45, v74, v75
    v_exp_f32 v78, v78
    v_exp_f32 v79, v79
    v_cvt_pk_bf16_f32 v46, v76, v77
    v_cvt_pk_bf16_f32 v47, v78, v79
    s_nop 1
    v_mfma_f32_32x32x16_bf16 v[80:95], v[36:39], v[44:47], v[80:95]
    s_mov_b64 exec, s[46:47]
    ds_read_b128 v[24:27], v15 offset:16384
    ds_read_b128 v[28:31], v15 offset:16896
    s_mov_b64 exec, -1
L_att_step6:
    v_exp_f32 v48, v48
    v_exp_f32 v49, v49
    v_exp_f32 v50, v50
    v_exp_f32_e64 v51, v51
    v_cvt_pk_bf16_f32 v40, v48, v49
    v_cvt_pk_bf16_f32 v41, v50, v51
    s_waitcnt lgkmcnt(0)
    v_mfma_f32_32x32x16_bf16 v[64:79], v[20:23], v[4:7], 0
    v_exp_f32 v52, v52
    v_exp_f32 v53, v53
    v_exp_f32 v54, v54
    v_exp_f32_e64 v55, v55
    v_cvt_pk_bf16_f32 v42, v52, v53
    v_cvt_pk_bf16_f32 v43, v54, v55
    ds_read_b128 v[16:19], v13 offset:32768
    v_exp_f32 v56, v56
    v_exp_f32 v57, v57
    v_mfma_f32_32x32x16_bf16 v[80:95], v[24:27], v[40:43], v[80:95]
    v_exp_f32 v58, v58
    v_exp_f32 v59, v59
    v_exp_f32 v60, v60
    v_exp_f32 v61, v61
    s_cmp_eq_u32 s93, 0
    s_cbranch_scc1 L34_nwo
    s_add_u32 m0, s55, 5120
    s_mov_b32 s56, 40960
    buffer_load_dwordx4 v128, s[16:19], s56 offen lds
L34_nwo:
    v_cvt_pk_bf16_f32 v44, v56, v57
    v_cvt_pk_bf16_f32 v45, v58, v59
    v_exp_f32 v62, v62
    v_exp_f32 v63, v63
    v_cvt_pk_bf16_f32 v46, v60, v61
    v_cvt_pk_bf16_f32 v47, v62, v63
    s_nop 1
    v_mfma_f32_32x32x16_bf16 v[80:95], v[28:31], v[44:47], v[80:95]
    s_mov_b64 exec, s[46:47]
    ds_read_b128 v[32:35], v15 offset:24576
    ds_read_b128 v[36:39], v15 offset:25088
    s_mov_b64 exec, -1
L_att_step7:
    v_exp_f32 v64, v64
    v_exp_f32 v65, v65
    v_exp_f32 v66, v66
    v_exp_f32_e64 v67, v67
    v_cvt_pk_bf16_f32 v40, v64, v65
    v_cvt_pk_bf16_f32 v41, v66, v67
    s_waitcnt lgkmcnt(0)
    v_mfma_f32_32x32x16_bf16 v[48:63], v[16:19], v[4:7], v[96:111]
    v_exp_f32 v68, v68
    v_exp_f32 v69, v69
    v_exp_f32 v70, v70
    v_exp_f32_e64 v71, v71
    v_cvt_pk_bf16_f32 v42, v68, v69
    v_cvt_pk_bf16_f32 v43, v70, v71
    v_exp_f32 v72, v72
    v_exp_f32 v73, v73
    v_mfma_f32_32x32x16_bf16 v[80:95], v[32:35], v[40:43], v[80:95]
    v_exp_f32 v74, v74
    v_exp_f32 v75, v75
    v_exp_f32 v76, v76
    v_exp_f32 v77, v77
    s_cmp_eq_u32 s93, 0
    s_cbranch_scc1 L35_nwo
    s_add_u32 m0, s55, 6144
    s_mov_b32 s56, 49152
    buffer_load_dwordx4 v128, s[16:19], s56 offen lds
L35_nwo:
    v_cvt_pk_bf16_f32 v44, v72, v73
    v_cvt_pk_bf16_f32 v45, v74, v75
    v_exp_f32 v78, v78
    v_exp_f32 v79, v79
    v_cvt_pk_bf16_f32 v46, v76, v77
    v_cvt_pk_bf16_f32 v47, v78, v79
    s_nop 1
    v_mfma_f32_32x32x16_bf16 v[80:95], v[36:39], v[44:47], v[80:95]
    s_mov_b64 exec, s[46:47]
    ds_read_b128 v[24:27], v15 offset:32768
    ds_read_b128 v[28:31], v15 offset:33280
    s_mov_b64 exec, -1
L_att_step8:
    s_nop 0
    v_exp_f32 v48, v48
    v_exp_f32 v49, v49
    v_exp_f32 v50, v50
    v_exp_f32 v51, v51
    v_cvt_pk_bf16_f32 v40, v48, v49
    v_cvt_pk_bf16_f32 v41, v50, v51
    s_waitcnt lgkmcnt(0)
    v_exp_f32 v52, v52
    v_exp_f32 v53, v53
    v_exp_f32 v54, v54
    v_exp_f32_e64 v55, v55
    v_cvt_pk_bf16_f32 v42, v52, v53
    v_cvt_pk_bf16_f32 v43, v54, v55
    v_exp_f32 v56, v56
    v_exp_f32 v57, v57
    v_mfma_f32_32x32x16_bf16 v[80:95], v[24:27], v[40:43], v[80:95]
    v_exp_f32 v58, v58
    v_exp_f32 v59, v59
    v_exp_f32 v60, v60
    v_exp_f32 v61, v61
    s_cmp_eq_u32 s93, 0
    s_cbranch_scc1 L36_nwo
    s_add_u32 m0, s55, 7168
    s_mov_b32 s56, 57344
    buffer_load_dwordx4 v128, s[16:19], s56 offen lds
L36_nwo:
    v_cvt_pk_bf16_f32 v44, v56, v57
    v_cvt_pk_bf16_f32 v45, v58, v59
    v_exp_f32 v62, v62
    v_exp_f32 v63, v63
    v_cvt_pk_bf16_f32 v46, v60, v61
    v_cvt_pk_bf16_f32 v47, v62, v63
    s_nop 1
    v_mfma_f32_32x32x16_bf16 v[80:95], v[28:31], v[44:47], v[80:95]
    s_nop 11
    v_cmp_gt_f32 vcc, 0x2b800000, v88
    s_nop 1
    s_mov_b64 s[48:49], vcc
    v_cmp_nge_f32 vcc, 0x53800000, v88
    s_nop 1
    s_or_b64 s[48:49], s[48:49], vcc
    s_cmp_eq_u64 s[48:49], 0
    s_cbranch_scc0 L_att_slow
L_att_fin:
    s_nop 7
    v_rcp_f32 v1, v88
    s_nop 0
    v_mul_f32 v80, v1, v80
    v_mul_f32 v81, v1, v81
    v_mul_f32 v82, v1, v82
    v_mul_f32 v83, v1, v83
    v_mul_f32 v84, v1, v84
    v_mul_f32 v85, v1, v85
    v_mul_f32 v86, v1, v86
    v_mul_f32_e64 v87, v1, v87
    v_cvt_pk_bf16_f32 v8, v80, v81
    v_cvt_pk_bf16_f32 v9, v82, v83
    v_cvt_pk_bf16_f32 v10, v84, v85
    v_cvt_pk_bf16_f32 v11, v86, v87
    s_lshl_b32 s50, s45, 5
    s_lshl_b32 s51, s40, 2
    s_add_u32 s50, s50, s51
    s_add_u32 s50, s50, s44
    s_lshl_b32 s50, s50, 10
    s_add_u32 s50, s50, 0x800000
    v_lshlrev_b32 v2, 4, v0
    buffer_store_dwordx4 v[8:11], v2, s[12:15], s50 offen sc1
    v_and_b32 v2, 7, v0
    v_lshlrev_b32 v2, 3, v2
    v_add_u32 v214, 0xa09000, v2
    buffer_load_dwordx2 v[212:213], v214, s[12:15], 0 offen sc1
    s_cmp_lg_u32 s69, 0
    s_cbranch_scc1 L_fnext
L_att_done:
    s_mov_b32 s86, 65536
    s_mov_b32 s87, 131072
    s_waitcnt vmcnt(0) lgkmcnt(0)
    s_barrier
    s_cmp_lg_u32 s38, 0
    s_cbranch_scc1 L45_noflag
    s_lshl_b32 s3, s39, 3
    s_add_u32 s3, s3, s40
    s_lshl_b32 s3, s3, 7
    s_add_u32 s3, s3, 0xa18000
    v_mov_b32 v2, s3
    v_mov_b32 v3, s41
    s_mov_b64 exec, 1
    buffer_store_dword v3, v2, s[12:15], 0 offen sc1
    s_mov_b64 exec, -1
L45_noflag:
    v_mov_b32 v36, 0
    v_mov_b32 v37, 0
    v_mov_b32 v38, 0
    v_mov_b32 v39, 0
    v_lshlrev_b32 v22, 4, v208
    v_add_u32_e64 v23, s87, v22
    ds_write_b128 v23, v[36:39]
    s_and_b32 s43, s38, 3
    s_lshl_b32 s44, s43, 1
    s_lshl_b32 s3, s39, 3
    s_add_u32 s3, s3, s44
    s_lshl_b32 s3, s3, 7
    s_add_u32 s3, s3, 0xa18000
    v_lshl_add_u32 v2, v0, 7, s3
    s_mov_b64 exec, 3
    s_mov_b32 s58, 20000
L46_poll:
    buffer_load_dword v3, v2, s[12:15], 0 offen sc1
    s_waitcnt vmcnt(0)
    v_cmp_ne_u32 vcc, s41, v3
    s_nop 1
    s_cbranch_vccz L47_polld
    s_sub_u32 s58, s58, 1
    s_cmp_lg_u32 s58, 0
    s_cbranch_scc1 L46_poll
L47_polld:
    s_mov_b64 exec, -1
    s_lshr_b32 s45, s38, 2
    s_lshl_b32 s46, s39, 1
    s_add_u32 s46, s46, s45
    s_lshl_b32 s46, s46, 5
    s_lshl_b32 s47, s43, 3
    s_add_u32 s46, s46, s47
    s_lshl_b32 s46, s46, 10
    s_add_u32 s46, s46, 0x800000
    s_lshl_b32 s44, s38, 13
    v_lshlrev_b32_e64 v4, 4, v0
    s_add_u32 m0, s44, 65536
    s_add_u32 s47, s46, 0
    s_nop 0
    buffer_load_dwordx4 v4, s[12:15], s47 offen sc1 lds
    s_add_u32 m0, s44, 66560
    s_add_u32 s47, s46, 1024
    buffer_load_dwordx4 v4, s[12:15], s47 offen sc1 lds
    s_add_u32 m0, s44, 67584
    s_add_u32 s47, s46, 2048
    buffer_load_dwordx4 v4, s[12:15], s47 offen sc1 lds
    s_add_u32 m0, s44, 68608
    s_add_u32 s47, s46, 3072
    buffer_load_dwordx4 v4, s[12:15], s47 offen sc1 lds
    s_add_u32 m0, s44, 69632
    s_add_u32 s47, s46, 4096
    buffer_load_dwordx4 v4, s[12:15], s47 offen sc1 lds
    s_add_u32 m0, s44, 70656
    s_add_u32 s47, s46, 5120
    buffer_load_dwordx4 v4, s[12:15], s47 offen sc1 lds
    s_add_u32 m0, s44, 71680
    s_add_u32 s47, s46, 6144
    buffer_load_dwordx4 v4, s[12:15], s47 offen sc1 lds
    s_add_u32 m0, s44, 72704
    s_add_u32 s47, s46, 7168
    buffer_load_dwordx4 v4, s[12:15], s47 offen sc1 lds
    s_cmp_ge_u32 s38, 4
    s_cbranch_scc1 L48_nofr
    s_lshr_b32 s44, s38, 1
    v_lshrrev_b32 v1, 5, v0
    v_lshlrev_b32_e64 v1, 2, v1
    v_bfe_u32 v2, v0, 2, 2
    v_add_u32 v1, v1, v2
    v_lshlrev_b32 v5, 7, v1
    v_bfe_u32 v1, v0, 4, 1
    v_lshlrev_b32_e64 v1, 1, v1
    v_bfe_u32 v2, v0, 1, 1
    v_add_u32 v1, v1, v2
    s_lshl_b32 s3, s44, 2
    v_add_u32_e64 v1, s3, v1
    v_bfe_u32 v2, v0, 3, 1
    v_lshlrev_b32 v2, 2, v2
    v_xor_b32 v1, v1, v2
    v_lshl_add_u32 v5, v1, 4, v5
    v_and_b32_e64 v1, 1, v0
    v_lshl_add_u32 v5, v1, 3, v5
    ds_read_b64_tr_b16 v[72:73], v5 offset:0
    ds_read_b64_tr_b16 v[74:75], v5 offset:1024
    ds_read_b64_tr_b16 v[76:77], v5 offset:2048
    ds_read_b64_tr_b16 v[78:79], v5 offset:3072
    ds_read_b64_tr_b16 v[80:81], v5 offset:4096
    ds_read_b64_tr_b16 v[82:83], v5 offset:5120
    ds_read_b64_tr_b16 v[84:85], v5 offset:6144
    ds_read_b64_tr_b16 v[86:87], v5 offset:7168
    ds_read_b64_tr_b16 v[88:89], v5 offset:8192
    ds_read_b64_tr_b16 v[90:91], v5 offset:9216
    ds_read_b64_tr_b16 v[92:93], v5 offset:10240
    ds_read_b64_tr_b16 v[94:95], v5 offset:11264
    ds_read_b64_tr_b16 v[96:97], v5 offset:12288
    ds_read_b64_tr_b16 v[98:99], v5 offset:13312
    ds_read_b64_tr_b16 v[100:101], v5 offset:14336
    ds_read_b64_tr_b16 v[102:103], v5 offset:15360
    ds_read_b64_tr_b16 v[104:105], v5 offset:16384
    ds_read_b64_tr_b16 v[106:107], v5 offset:17408
    ds_read_b64_tr_b16 v[108:109], v5 offset:18432
    ds_read_b64_tr_b16 v[110:111], v5 offset:19456
    ds_read_b64_tr_b16 v[112:113], v5 offset:20480
    ds_read_b64_tr_b16 v[114:115], v5 offset:21504
    ds_read_b64_tr_b16 v[116:117], v5 offset:22528
    ds_read_b64_tr_b16 v[118:119], v5 offset:23552
    ds_read_b64_tr_b16 v[120:121], v5 offset:24576
    ds_read_b64_tr_b16 v[122:123], v5 offset:25600
    ds_read_b64_tr_b16 v[124:125], v5 offset:26624
    ds_read_b64_tr_b16 v[126:127], v5 offset:27648
    ds_read_b64_tr_b16 v[128:129], v5 offset:28672
    ds_read_b64_tr_b16 v[130:131], v5 offset:29696
    ds_read_b64_tr_b16 v[132:133], v5 offset:30720
    ds_read_b64_tr_b16 v[134:135], v5 offset:31744
    ds_read_b64_tr_b16 v[136:137], v5 offset:32768
    ds_read_b64_tr_b16 v[138:139], v5 offset:33792
    ds_read_b64_tr_b16 v[140:141], v5 offset:34816
    ds_read_b64_tr_b16 v[142:143], v5 offset:35840
    ds_read_b64_tr_b16 v[144:145], v5 offset:36864
    ds_read_b64_tr_b16 v[146:147], v5 offset:37888
    ds_read_b64_tr_b16 v[148:149], v5 offset:38912
    ds_read_b64_tr_b16 v[150:151], v5 offset:39936
    ds_read_b64_tr_b16 v[152:153], v5 offset:40960
    ds_read_b64_tr_b16 v[154:155], v5 offset:41984
    ds_read_b64_tr_b16 v[156:157], v5 offset:43008
    ds_read_b64_tr_b16 v[158:159], v5 offset:44032
    ds_read_b64_tr_b16 v[160:161], v5 offset:45056
    ds_read_b64_tr_b16 v[162:163], v5 offset:46080
    ds_read_b64_tr_b16 v[164:165], v5 offset:47104
    ds_read_b64_tr_b16 v[166:167], v5 offset:48128
    ds_read_b64_tr_b16 v[168:169], v5 offset:49152
    ds_read_b64_tr_b16 v[170:171], v5 offset:50176
    ds_read_b64_tr_b16 v[172:173], v5 offset:51200
    ds_read_b64_tr_b16 v[174:175], v5 offset:52224
    ds_read_b64_tr_b16 v[176:177], v5 offset:53248
    ds_read_b64_tr_b16 v[178:179], v5 offset:54272
    ds_read_b64_tr_b16 v[180:181], v5 offset:55296
    ds_read_b64_tr_b16 v[182:183], v5 offset:56320
    ds_read_b64_tr_b16 v[184:185], v5 offset:57344
    ds_read_b64_tr_b16 v[186:187], v5 offset:58368
    ds_read_b64_tr_b16 v[188:189], v5 offset:59392
    ds_read_b64_tr_b16 v[190:191], v5 offset:60416
    ds_read_b64_tr_b16 v[192:193], v5 offset:61440
    ds_read_b64_tr_b16 v[194:195], v5 offset:62464
    ds_read_b64_tr_b16 v[196:197], v5 offset:63488
    ds_read_b64_tr_b16 v[198:199], v5 offset:64512
L48_nofr:
    s_waitcnt vmcnt(0) lgkmcnt(0)
    s_barrier
    s_cmp_ge_u32 s38, 4
    s_cbranch_scc1 L_yred
L_gemm:
    s_and_b32 s43, s38, 1
    s_lshr_b32 s44, s38, 1
    s_lshl_b32 s3, s43, 15
    s_add_u32 s3, s3, s86
    v_lshl_add_u32 v6, v0, 4, s3
    ds_read_b128 v[56:59], v6 offset:0
    ds_read_b128 v[60:63], v6 offset:1024
    ds_read_b128 v[64:67], v6 offset:2048
    s_waitcnt lgkmcnt(2)
    v_mfma_f32_32x32x16_bf16 v[40:55], v[72:75], v[56:59], 0
    ds_read_b128 v[56:59], v6 offset:3072
    s_waitcnt lgkmcnt(2)
    v_mfma_f32_32x32x16_bf16 v[40:55], v[76:79], v[60:63], v[40:55]
    ds_read_b128 v[60:63], v6 offset:4096
    s_waitcnt lgkmcnt(2)
    v_mfma_f32_32x32x16_bf16 v[40:55], v[80:83], v[64:67], v[40:55]
    ds_read_b128 v[64:67], v6 offset:5120
    s_waitcnt lgkmcnt(2)
    v_mfma_f32_32x32x16_bf16 v[40:55], v[84:87], v[56:59], v[40:55]
    ds_read_b128 v[56:59], v6 offset:6144
    s_waitcnt lgkmcnt(2)
    v_mfma_f32_32x32x16_bf16 v[40:55], v[88:91], v[60:63], v[40:55]
    ds_read_b128 v[60:63], v6 offset:7168
    s_waitcnt lgkmcnt(2)
    v_mfma_f32_32x32x16_bf16 v[40:55], v[92:95], v[64:67], v[40:55]
    ds_read_b128 v[64:67], v6 offset:8192
    s_waitcnt lgkmcnt(2)
    v_mfma_f32_32x32x16_bf16 v[40:55], v[96:99], v[56:59], v[40:55]
    ds_read_b128 v[56:59], v6 offset:9216
    s_waitcnt lgkmcnt(2)
    v_mfma_f32_32x32x16_bf16 v[40:55], v[100:103], v[60:63], v[40:55]
    ds_read_b128 v[60:63], v6 offset:10240
    s_waitcnt lgkmcnt(2)
    v_mfma_f32_32x32x16_bf16 v[40:55], v[104:107], v[64:67], v[40:55]
    ds_read_b128 v[64:67], v6 offset:11264
    s_waitcnt lgkmcnt(2)
    v_mfma_f32_32x32x16_bf16 v[40:55], v[108:111], v[56:59], v[40:55]
    ds_read_b128 v[56:59], v6 offset:12288
    s_waitcnt lgkmcnt(2)
    v_mfma_f32_32x32x16_bf16 v[40:55], v[112:115], v[60:63], v[40:55]
    ds_read_b128 v[60:63], v6 offset:13312
    s_waitcnt lgkmcnt(2)
    v_mfma_f32_32x32x16_bf16 v[40:55], v[116:119], v[64:67], v[40:55]
    ds_read_b128 v[64:67], v6 offset:14336
    s_waitcnt lgkmcnt(2)
    v_mfma_f32_32x32x16_bf16 v[40:55], v[120:123], v[56:59], v[40:55]
    ds_read_b128 v[56:59], v6 offset:15360
    s_waitcnt lgkmcnt(2)
    v_mfma_f32_32x32x16_bf16 v[40:55], v[124:127], v[60:63], v[40:55]
    ds_read_b128 v[60:63], v6 offset:16384
    s_waitcnt lgkmcnt(2)
    v_mfma_f32_32x32x16_bf16 v[40:55], v[128:131], v[64:67], v[40:55]
    ds_read_b128 v[64:67], v6 offset:17408
    s_waitcnt lgkmcnt(2)
    v_mfma_f32_32x32x16_bf16 v[40:55], v[132:135], v[56:59], v[40:55]
    ds_read_b128 v[56:59], v6 offset:18432
    s_waitcnt lgkmcnt(2)
    v_mfma_f32_32x32x16_bf16 v[40:55], v[136:139], v[60:63], v[40:55]
    ds_read_b128 v[60:63], v6 offset:19456
    s_waitcnt lgkmcnt(2)
    v_mfma_f32_32x32x16_bf16 v[40:55], v[140:143], v[64:67], v[40:55]
    ds_read_b128 v[64:67], v6 offset:20480
    s_waitcnt lgkmcnt(2)
    v_mfma_f32_32x32x16_bf16 v[40:55], v[144:147], v[56:59], v[40:55]
    ds_read_b128 v[56:59], v6 offset:21504
    s_waitcnt lgkmcnt(2)
    v_mfma_f32_32x32x16_bf16 v[40:55], v[148:151], v[60:63], v[40:55]
    ds_read_b128 v[60:63], v6 offset:22528
    s_waitcnt lgkmcnt(2)
    v_mfma_f32_32x32x16_bf16 v[40:55], v[152:155], v[64:67], v[40:55]
    ds_read_b128 v[64:67], v6 offset:23552
    s_waitcnt lgkmcnt(2)
    v_mfma_f32_32x32x16_bf16 v[40:55], v[156:159], v[56:59], v[40:55]
    ds_read_b128 v[56:59], v6 offset:24576
    s_waitcnt lgkmcnt(2)
    v_mfma_f32_32x32x16_bf16 v[40:55], v[160:163], v[60:63], v[40:55]
    ds_read_b128 v[60:63], v6 offset:25600
    s_waitcnt lgkmcnt(2)
    v_mfma_f32_32x32x16_bf16 v[40:55], v[164:167], v[64:67], v[40:55]
    ds_read_b128 v[64:67], v6 offset:26624
    s_waitcnt lgkmcnt(2)
    v_mfma_f32_32x32x16_bf16 v[40:55], v[168:171], v[56:59], v[40:55]
    ds_read_b128 v[56:59], v6 offset:27648
    s_waitcnt lgkmcnt(2)
    v_mfma_f32_32x32x16_bf16 v[40:55], v[172:175], v[60:63], v[40:55]
    ds_read_b128 v[60:63], v6 offset:28672
    s_waitcnt lgkmcnt(2)
    v_mfma_f32_32x32x16_bf16 v[40:55], v[176:179], v[64:67], v[40:55]
    ds_read_b128 v[64:67], v6 offset:29696
    s_waitcnt lgkmcnt(2)
    v_mfma_f32_32x32x16_bf16 v[40:55], v[180:183], v[56:59], v[40:55]
    ds_read_b128 v[56:59], v6 offset:30720
    s_waitcnt lgkmcnt(2)
    v_mfma_f32_32x32x16_bf16 v[40:55], v[184:187], v[60:63], v[40:55]
    ds_read_b128 v[60:63], v6 offset:31744
    s_waitcnt lgkmcnt(2)
    v_mfma_f32_32x32x16_bf16 v[40:55], v[188:191], v[64:67], v[40:55]
    s_waitcnt lgkmcnt(1)
    v_mfma_f32_32x32x16_bf16 v[40:55], v[192:195], v[56:59], v[40:55]
    s_waitcnt lgkmcnt(0)
    v_mfma_f32_32x32x16_bf16 v[40:55], v[196:199], v[60:63], v[40:55]
    v_and_b32 v1, 31, v0
    s_lshl_b32 s3, s43, 5
    v_add_u32_e64 v1, s3, v1
    v_mul_u32_u24 v1, 0x90, v1
    v_lshrrev_b32_e64 v2, 5, v0
    v_lshl_add_u32 v1, v2, 3, v1
    s_lshl_b32 s3, s44, 6
    s_add_u32 s3, s3, 147456
    v_add_u32_e64 v1, s3, v1
    s_nop 2
    v_cvt_pk_bf16_f32 v56, v40, v41
    v_cvt_pk_bf16_f32 v57, v42, v43
    ds_write_b64 v1, v[56:57] offset:0
    v_cvt_pk_bf16_f32 v58, v44, v45
    v_cvt_pk_bf16_f32 v59, v46, v47
    ds_write_b64 v1, v[58:59] offset:16
    v_cvt_pk_bf16_f32 v60, v48, v49
    v_cvt_pk_bf16_f32 v61, v50, v51
    ds_write_b64 v1, v[60:61] offset:32
    v_cvt_pk_bf16_f32 v62, v52, v53
    v_cvt_pk_bf16_f32 v63, v54, v55
    ds_write_b64 v1, v[62:63] offset:48
    s_branch L_gdone
L_yred:
    s_cmp_lt_u32 s54, 28
    s_cbranch_scc1 L_selpoll
    v_cmp_ne_u32 vcc, s41, v213
    s_nop 1
    s_cbranch_vccz L_selok
L_selpoll:
    v_and_b32 v2, 7, v0
    v_lshlrev_b32 v2, 3, v2
    v_add_u32 v214, 0xa09000, v2
    s_mov_b32 s58, 20000
L49_poll:
    buffer_load_dwordx2 v[212:213], v214, s[12:15], 0 offen sc1
    s_waitcnt vmcnt(0)
    v_cmp_ne_u32 vcc, s41, v213
    s_nop 1
    s_cbranch_vccz L50_polld
    s_sub_u32 s58, s58, 1
    s_cmp_lg_u32 s58, 0
    s_cbranch_scc1 L49_poll
L50_polld:
L_selok:
    v_mov_b32 v32, v212
    s_mov_b32 s60, 0
    s_sub_u32 s3, s38, 4
    v_readlane_b32 s48, v32, s3
    s_nop 1
    s_lshr_b32 s49, s48, 16
    s_lshl_b32 s49, s49, 16
    s_and_b32 s48, s48, 0xffff
    s_lshr_b32 s50, s48, 6
    s_cmp_lg_u32 s50, s39
    s_cbranch_scc1 L51_noy
    s_mov_b32 s51, s3
    v_lshlrev_b32 v2, 7, v0
    v_add_u32 v2, 0xa20000, v2
    s_mov_b64 exec, 0xfffffff
    s_mov_b32 s58, 20000
L52_poll:
    buffer_load_dword v3, v2, s[12:15], 0 offen sc1
    s_waitcnt vmcnt(0)
    v_cmp_ne_u32 vcc, s41, v3
    s_nop 1
    s_cbranch_vccz L53_polld
    s_sub_u32 s58, s58, 1
    s_cmp_lg_u32 s58, 0
    s_cbranch_scc1 L52_poll
L53_polld:
    s_mov_b64 exec, -1
    v_lshrrev_b32 v1, 4, v0
    v_lshlrev_b32 v1, 14, v1
    v_bfe_u32 v2, v0, 1, 3
    v_lshl_add_u32 v1, v2, 6, v1
    v_and_b32_e64 v2, 1, v0
    v_lshl_add_u32 v1, v2, 4, v1
    s_lshl_b32 s3, s51, 11
    s_lshr_b32 s50, s40, 1
    s_lshl_b32 s50, s50, 9
    s_add_u32 s3, s3, s50
    s_and_b32 s50, s40, 1
    s_lshl_b32 s50, s50, 5
    s_add_u32 s3, s3, s50
    s_add_u32 s3, s3, 0xa30000
    s_add_u32 s50, s3, 0
    buffer_load_dwordx4 v[40:43], v1, s[12:15], s50 offen sc1
    s_add_u32 s50, s3, 65536
    buffer_load_dwordx4 v[44:47], v1, s[12:15], s50 offen sc1
    s_add_u32 s50, s3, 131072
    buffer_load_dwordx4 v[48:51], v1, s[12:15], s50 offen sc1
    s_add_u32 s50, s3, 196608
    buffer_load_dwordx4 v[52:55], v1, s[12:15], s50 offen sc1
    s_add_u32 s50, s3, 262144
    buffer_load_dwordx4 v[56:59], v1, s[12:15], s50 offen sc1
    s_add_u32 s50, s3, 327680
    buffer_load_dwordx4 v[60:63], v1, s[12:15], s50 offen sc1
    s_add_u32 s50, s3, 393216
    buffer_load_dwordx4 v[64:67], v1, s[12:15], s50 offen sc1
    s_waitcnt vmcnt(0)
    v_add_f32 v40, v40, v44
    v_add_f32 v41, v41, v45
    v_add_f32 v42, v42, v46
    v_add_f32 v43, v43, v47
    v_add_f32 v40, v40, v48
    v_add_f32 v41, v41, v49
    v_add_f32 v42, v42, v50
    v_add_f32 v43, v43, v51
    v_add_f32 v40, v40, v52
    v_add_f32 v41, v41, v53
    v_add_f32 v42, v42, v54
    v_add_f32 v43, v43, v55
    v_add_f32 v40, v40, v56
    v_add_f32 v41, v41, v57
    v_add_f32 v42, v42, v58
    v_add_f32 v43, v43, v59
    v_add_f32 v40, v40, v60
    v_add_f32 v41, v41, v61
    v_add_f32 v42, v42, v62
    v_add_f32 v43, v43, v63
    v_add_f32 v40, v40, v64
    v_add_f32 v41, v41, v65
    v_add_f32 v42, v42, v66
    v_add_f32 v43, v43, v67
    v_mov_b32 v1, v40
    s_nop 1
    v_permlane16_swap_b32 v40, v1
    v_add_f32 v40, v40, v1
    v_mov_b32 v1, v40
    s_nop 1
    v_permlane32_swap_b32 v40, v1
    v_add_f32_e64 v40, v40, v1
    v_cvt_pk_bf16_f32 v40, 0, v40
    v_mul_f32 v40, s49, v40
    v_mov_b32 v1, v41
    s_nop 1
    v_permlane16_swap_b32 v41, v1
    v_add_f32 v41, v41, v1
    v_mov_b32 v1, v41
    s_nop 1
    v_permlane32_swap_b32 v41, v1
    v_add_f32_e64 v41, v41, v1
    v_cvt_pk_bf16_f32 v41, 0, v41
    v_mul_f32 v41, s49, v41
    v_mov_b32 v1, v42
    s_nop 1
    v_permlane16_swap_b32 v42, v1
    v_add_f32 v42, v42, v1
    v_mov_b32 v1, v42
    s_nop 1
    v_permlane32_swap_b32 v42, v1
    v_add_f32_e64 v42, v42, v1
    v_cvt_pk_bf16_f32 v42, 0, v42
    v_mul_f32 v42, s49, v42
    v_mov_b32 v1, v43
    s_nop 1
    v_permlane16_swap_b32 v43, v1
    v_add_f32 v43, v43, v1
    v_mov_b32 v1, v43
    s_nop 1
    v_permlane32_swap_b32 v43, v1
    v_add_f32_e64 v43, v43, v1
    v_cvt_pk_bf16_f32 v43, 0, v43
    v_mul_f32 v43, s49, v43
    s_and_b32 s3, s48, 63
    s_lshl_b32 s3, s3, 7
    s_add_u32 s3, s3, s87
    v_and_b32 v2, 1, v0
    v_lshlrev_b32 v2, 6, v2
    v_bfe_u32 v1, v0, 1, 3
    v_lshl_add_u32 v2, v1, 1, v2
    v_add_u32_e64 v2, s3, v2
    v_cvt_pk_bf16_f32 v40, v40, 0
    v_cvt_pk_bf16_f32 v41, v41, 0
    v_cvt_pk_bf16_f32 v42, v42, 0
    v_cvt_pk_bf16_f32 v43, v43, 0
    s_mov_b64 exec, 0xffff
    ds_write_b16 v2, v40 offset:0
    ds_write_b16 v2, v41 offset:16
    ds_write_b16 v2, v42 offset:32
    ds_write_b16 v2, v43 offset:48
    s_mov_b64 exec, -1
L51_noy:
    s_sub_u32 s3, s38, 0
    v_readlane_b32 s48, v32, s3
    s_nop 1
    s_lshr_b32 s49, s48, 16
    s_lshl_b32 s49, s49, 16
    s_and_b32 s48, s48, 0xffff
    s_lshr_b32 s50, s48, 6
    s_cmp_lg_u32 s50, s39
    s_cbranch_scc1 L54_noy
    s_mov_b32 s51, s3
    v_lshlrev_b32 v2, 7, v0
    v_add_u32 v2, 0xa20000, v2
    s_mov_b64 exec, 0xfffffff
    s_mov_b32 s58, 20000
L55_poll:
    buffer_load_dword v3, v2, s[12:15], 0 offen sc1
    s_waitcnt vmcnt(0)
    v_cmp_ne_u32 vcc, s41, v3
    s_nop 1
    s_cbranch_vccz L56_polld
    s_sub_u32 s58, s58, 1
    s_cmp_lg_u32 s58, 0
    s_cbranch_scc1 L55_poll
L56_polld:
    s_mov_b64 exec, -1
    v_lshrrev_b32 v1, 4, v0
    v_lshlrev_b32 v1, 14, v1
    v_bfe_u32 v2, v0, 1, 3
    v_lshl_add_u32 v1, v2, 6, v1
    v_and_b32_e64 v2, 1, v0
    v_lshl_add_u32 v1, v2, 4, v1
    s_lshl_b32 s3, s51, 11
    s_lshr_b32 s50, s40, 1
    s_lshl_b32 s50, s50, 9
    s_add_u32 s3, s3, s50
    s_and_b32 s50, s40, 1
    s_lshl_b32 s50, s50, 5
    s_add_u32 s3, s3, s50
    s_add_u32 s3, s3, 0xa30000
    s_add_u32 s50, s3, 0
    buffer_load_dwordx4 v[40:43], v1, s[12:15], s50 offen sc1
    s_add_u32 s50, s3, 65536
    buffer_load_dwordx4 v[44:47], v1, s[12:15], s50 offen sc1
    s_add_u32 s50, s3, 131072
    buffer_load_dwordx4 v[48:51], v1, s[12:15], s50 offen sc1
    s_add_u32 s50, s3, 196608
    buffer_load_dwordx4 v[52:55], v1, s[12:15], s50 offen sc1
    s_add_u32 s50, s3, 262144
    buffer_load_dwordx4 v[56:59], v1, s[12:15], s50 offen sc1
    s_add_u32 s50, s3, 327680
    buffer_load_dwordx4 v[60:63], v1, s[12:15], s50 offen sc1
    s_add_u32 s50, s3, 393216
    buffer_load_dwordx4 v[64:67], v1, s[12:15], s50 offen sc1
    s_waitcnt vmcnt(0)
    v_add_f32 v40, v40, v44
    v_add_f32 v41, v41, v45
    v_add_f32 v42, v42, v46
    v_add_f32 v43, v43, v47
    v_add_f32 v40, v40, v48
    v_add_f32 v41, v41, v49
    v_add_f32 v42, v42, v50
    v_add_f32 v43, v43, v51
    v_add_f32 v40, v40, v52
    v_add_f32 v41, v41, v53
    v_add_f32 v42, v42, v54
    v_add_f32 v43, v43, v55
    v_add_f32 v40, v40, v56
    v_add_f32 v41, v41, v57
    v_add_f32 v42, v42, v58
    v_add_f32 v43, v43, v59
    v_add_f32 v40, v40, v60
    v_add_f32 v41, v41, v61
    v_add_f32 v42, v42, v62
    v_add_f32 v43, v43, v63
    v_add_f32 v40, v40, v64
    v_add_f32 v41, v41, v65
    v_add_f32 v42, v42, v66
    v_add_f32 v43, v43, v67
    v_mov_b32 v1, v40
    s_nop 1
    v_permlane16_swap_b32 v40, v1
    v_add_f32 v40, v40, v1
    v_mov_b32 v1, v40
    s_nop 1
    v_permlane32_swap_b32 v40, v1
    v_add_f32_e64 v40, v40, v1
    v_cvt_pk_bf16_f32 v40, 0, v40
    v_mul_f32 v40, s49, v40
    v_mov_b32 v1, v41
    s_nop 1
    v_permlane16_swap_b32 v41, v1
    v_add_f32 v41, v41, v1
    v_mov_b32 v1, v41
    s_nop 1
    v_permlane32_swap_b32 v41, v1
    v_add_f32_e64 v41, v41, v1
    v_cvt_pk_bf16_f32 v41, 0, v41
    v_mul_f32 v41, s49, v41
    v_mov_b32 v1, v42
    s_nop 1
    v_permlane16_swap_b32 v42, v1
    v_add_f32 v42, v42, v1
    v_mov_b32 v1, v42
    s_nop 1
    v_permlane32_swap_b32 v42, v1
    v_add_f32_e64 v42, v42, v1
    v_cvt_pk_bf16_f32 v42, 0, v42
    v_mul_f32 v42, s49, v42
    v_mov_b32 v1, v43
    s_nop 1
    v_permlane16_swap_b32 v43, v1
    v_add_f32 v43, v43, v1
    v_mov_b32 v1, v43
    s_nop 1
    v_permlane32_swap_b32 v43, v1
    v_add_f32_e64 v43, v43, v1
    v_cvt_pk_bf16_f32 v43, 0, v43
    v_mul_f32 v43, s49, v43
    s_and_b32 s3, s48, 63
    s_lshl_b32 s3, s3, 7
    s_add_u32 s3, s3, s87
    v_and_b32 v2, 1, v0
    v_lshlrev_b32 v2, 6, v2
    v_bfe_u32 v1, v0, 1, 3
    v_lshl_add_u32 v2, v1, 1, v2
    v_add_u32_e64 v2, s3, v2
    v_cvt_pk_bf16_f32 v40, v40, 0
    v_cvt_pk_bf16_f32 v41, v41, 0
    v_cvt_pk_bf16_f32 v42, v42, 0
    v_cvt_pk_bf16_f32 v43, v43, 0
    s_mov_b64 exec, 0xffff
    ds_write_b16 v2, v40 offset:0
    ds_write_b16 v2, v41 offset:16
    ds_write_b16 v2, v42 offset:32
    ds_write_b16 v2, v43 offset:48
    s_mov_b64 exec, -1
L54_noy:
L_gdone:
    v_lshlrev_b32 v1, 16, v200
    v_and_b32 v2, 0xffff0000, v200
    v_sub_f32 v1, v1, v210
    v_sub_f32 v2, v2, v210
    v_cvt_pk_bf16_f32 v7, v1, v2
    v_and_b32 v2, 0xffff0000, v7
    v_lshlrev_b32 v1, 16, v7
    v_mul_f32 v1, v211, v1
    v_mul_f32_e64 v2, v211, v2
    v_cvt_pk_bf16_f32 v216, v1, v2
    v_lshlrev_b32_e64 v1, 16, v201
    v_and_b32 v2, 0xffff0000, v201
    v_sub_f32 v1, v1, v210
    v_sub_f32 v2, v2, v210
    v_cvt_pk_bf16_f32 v7, v1, v2
    v_and_b32 v2, 0xffff0000, v7
    v_lshlrev_b32 v1, 16, v7
    v_mul_f32 v1, v211, v1
    v_mul_f32_e64 v2, v211, v2
    v_cvt_pk_bf16_f32 v217, v1, v2
    v_lshlrev_b32_e64 v1, 16, v202
    v_and_b32 v2, 0xffff0000, v202
    v_sub_f32 v1, v1, v210
    v_sub_f32 v2, v2, v210
    v_cvt_pk_bf16_f32 v7, v1, v2
    v_and_b32 v2, 0xffff0000, v7
    v_lshlrev_b32 v1, 16, v7
    v_mul_f32 v1, v211, v1
    v_mul_f32_e64 v2, v211, v2
    v_cvt_pk_bf16_f32 v218, v1, v2
    v_lshlrev_b32_e64 v1, 16, v203
    v_and_b32 v2, 0xffff0000, v203
    v_sub_f32 v1, v1, v210
    v_sub_f32 v2, v2, v210
    v_cvt_pk_bf16_f32 v7, v1, v2
    v_and_b32 v2, 0xffff0000, v7
    v_lshlrev_b32 v1, 16, v7
    v_mul_f32 v1, v211, v1
    v_mul_f32_e64 v2, v211, v2
    v_cvt_pk_bf16_f32 v219, v1, v2
    v_lshrrev_b32_e64 v1, 3, v208
    v_mul_u32_u24 v1, 0x90, v1
    v_and_b32_e64 v2, 7, v208
    v_lshl_add_u32 v1, v2, 4, v1
    v_add_u32 v9, 147456, v1
    s_waitcnt vmcnt(0) lgkmcnt(0)
    s_barrier
    ds_read_b128 v[40:43], v9
    ds_read_b128 v[44:47], v23
    s_waitcnt lgkmcnt(1)
    v_lshlrev_b32 v1, 16, v200
    v_and_b32 v2, 0xffff0000, v200
    v_lshlrev_b32_e64 v3, 16, v40
    v_and_b32 v4, 0xffff0000, v40
    v_add_f32 v1, v1, v3
    v_add_f32 v2, v2, v4
    v_cvt_pk_bf16_f32 v220, v1, v2
    v_lshlrev_b32_e64 v1, 16, v201
    v_and_b32 v2, 0xffff0000, v201
    v_lshlrev_b32_e64 v3, 16, v41
    v_and_b32 v4, 0xffff0000, v41
    v_add_f32 v1, v1, v3
    v_add_f32 v2, v2, v4
    v_cvt_pk_bf16_f32 v221, v1, v2
    v_lshlrev_b32_e64 v1, 16, v202
    v_and_b32 v2, 0xffff0000, v202
    v_lshlrev_b32_e64 v3, 16, v42
    v_and_b32 v4, 0xffff0000, v42
    v_add_f32 v1, v1, v3
    v_add_f32 v2, v2, v4
    v_cvt_pk_bf16_f32 v222, v1, v2
    v_lshlrev_b32_e64 v1, 16, v203
    v_and_b32 v2, 0xffff0000, v203
    v_lshlrev_b32_e64 v3, 16, v43
    v_and_b32 v4, 0xffff0000, v43
    v_add_f32 v1, v1, v3
    v_add_f32 v2, v2, v4
    v_cvt_pk_bf16_f32 v223, v1, v2
    s_waitcnt lgkmcnt(0)
    v_lshlrev_b32 v1, 16, v216
    v_and_b32 v2, 0xffff0000, v216
    v_lshlrev_b32_e64 v3, 16, v44
    v_and_b32 v4, 0xffff0000, v44
    v_add_f32 v1, v1, v3
    v_add_f32 v2, v2, v4
    v_cvt_pk_bf16_f32 v6, v1, v2
    v_lshlrev_b32_e64 v1, 16, v220
    v_and_b32 v2, 0xffff0000, v220
    v_lshlrev_b32_e64 v3, 16, v6
    v_and_b32 v4, 0xffff0000, v6
    v_add_f32 v1, v1, v3
    v_add_f32 v2, v2, v4
    v_cvt_pk_bf16_f32 v48, v1, v2
    v_lshlrev_b32_e64 v1, 16, v217
    v_and_b32 v2, 0xffff0000, v217
    v_lshlrev_b32_e64 v3, 16, v45
    v_and_b32 v4, 0xffff0000, v45
    v_add_f32 v1, v1, v3
    v_add_f32 v2, v2, v4
    v_cvt_pk_bf16_f32 v6, v1, v2
    v_lshlrev_b32_e64 v1, 16, v221
    v_and_b32 v2, 0xffff0000, v221
    v_lshlrev_b32_e64 v3, 16, v6
    v_and_b32 v4, 0xffff0000, v6
    v_add_f32 v1, v1, v3
    v_add_f32 v2, v2, v4
    v_cvt_pk_bf16_f32 v49, v1, v2
    v_lshlrev_b32_e64 v1, 16, v218
    v_and_b32 v2, 0xffff0000, v218
    v_lshlrev_b32_e64 v3, 16, v46
    v_and_b32 v4, 0xffff0000, v46
    v_add_f32 v1, v1, v3
    v_add_f32 v2, v2, v4
    v_cvt_pk_bf16_f32 v6, v1, v2
    v_lshlrev_b32_e64 v1, 16, v222
    v_and_b32 v2, 0xffff0000, v222
    v_lshlrev_b32_e64 v3, 16, v6
    v_and_b32 v4, 0xffff0000, v6
    v_add_f32 v1, v1, v3
    v_add_f32 v2, v2, v4
    v_cvt_pk_bf16_f32 v50, v1, v2
    v_lshlrev_b32_e64 v1, 16, v219
    v_and_b32 v2, 0xffff0000, v219
    v_lshlrev_b32_e64 v3, 16, v47
    v_and_b32 v4, 0xffff0000, v47
    v_add_f32 v1, v1, v3
    v_add_f32 v2, v2, v4
    v_cvt_pk_bf16_f32 v6, v1, v2
    v_lshlrev_b32_e64 v1, 16, v223
    v_and_b32 v2, 0xffff0000, v223
    v_lshlrev_b32_e64 v3, 16, v6
    v_and_b32 v4, 0xffff0000, v6
    v_add_f32 v1, v1, v3
    v_add_f32 v2, v2, v4
    v_cvt_pk_bf16_f32 v51, v1, v2
    buffer_store_dwordx4 v[48:51], v209, s[20:23], 0 offen sc1
L_exit:
    s_endpgm
L_csync:
    s_add_u32 s88, s39, s38
    s_cmp_lt_u32 s88, 4
    s_cbranch_scc1 L_cnb
    s_sub_u32 s88, s88, 4
    s_lshl_b32 s89, s88, 3
    s_add_u32 s89, s89, s40
    s_lshl_b32 s89, s89, 7
    s_add_u32 s89, s89, 0xa10000
    v_mov_b32 v2, s89
    s_mov_b64 exec, 1
    s_mov_b32 s58, 20000
L18_poll:
    buffer_load_dword v3, v2, s[12:15], 0 offen sc1
    s_waitcnt vmcnt(0)
    v_cmp_ne_u32 vcc, s41, v3
    s_nop 1
    s_cbranch_vccz L19_polld
    s_sub_u32 s58, s58, 1
    s_cmp_lg_u32 s58, 0
    s_cbranch_scc1 L18_poll
L19_polld:
    s_mov_b64 exec, -1
    s_lshl_b32 s90, s88, 6
    s_lshl_b32 s91, s40, 2
    s_add_u32 s90, s90, s91
    s_lshl_b32 s90, s90, 10
    s_add_u32 s90, s90, 0x400000
    s_lshl_b32 s91, s38, 14
    s_add_u32 s91, s91, 65536
    v_lshlrev_b32 v2, 4, v0
    s_add_u32 m0, s91, 8192
    s_add_u32 s92, s90, 32768
    buffer_load_dwordx4 v2, s[12:15], s92 offen sc1 lds
    s_add_u32 m0, s91, 9216
    s_add_u32 s92, s90, 2129920
    buffer_load_dwordx4 v2, s[12:15], s92 offen sc1 lds
    s_add_u32 m0, s91, 10240
    s_add_u32 s92, s90, 33792
    buffer_load_dwordx4 v2, s[12:15], s92 offen sc1 lds
    s_add_u32 m0, s91, 11264
    s_add_u32 s92, s90, 2130944
    buffer_load_dwordx4 v2, s[12:15], s92 offen sc1 lds
    s_add_u32 m0, s91, 12288
    s_add_u32 s92, s90, 34816
    buffer_load_dwordx4 v2, s[12:15], s92 offen sc1 lds
    s_add_u32 m0, s91, 13312
    s_add_u32 s92, s90, 2131968
    buffer_load_dwordx4 v2, s[12:15], s92 offen sc1 lds
    s_add_u32 m0, s91, 14336
    s_add_u32 s92, s90, 35840
    buffer_load_dwordx4 v2, s[12:15], s92 offen sc1 lds
    s_add_u32 m0, s91, 15360
    s_add_u32 s92, s90, 2132992
    buffer_load_dwordx4 v2, s[12:15], s92 offen sc1 lds
    s_add_u32 m0, s91, 0
    s_add_u32 s92, s90, 0
    buffer_load_dwordx4 v2, s[12:15], s92 offen sc1 lds
    s_add_u32 m0, s91, 1024
    s_add_u32 s92, s90, 2097152
    buffer_load_dwordx4 v2, s[12:15], s92 offen sc1 lds
    s_add_u32 m0, s91, 2048
    s_add_u32 s92, s90, 1024
    buffer_load_dwordx4 v2, s[12:15], s92 offen sc1 lds
    s_add_u32 m0, s91, 3072
    s_add_u32 s92, s90, 2098176
    buffer_load_dwordx4 v2, s[12:15], s92 offen sc1 lds
    s_add_u32 m0, s91, 4096
    s_add_u32 s92, s90, 2048
    buffer_load_dwordx4 v2, s[12:15], s92 offen sc1 lds
    s_add_u32 m0, s91, 5120
    s_add_u32 s92, s90, 2099200
    buffer_load_dwordx4 v2, s[12:15], s92 offen sc1 lds
    s_add_u32 m0, s91, 6144
    s_add_u32 s92, s90, 3072
    buffer_load_dwordx4 v2, s[12:15], s92 offen sc1 lds
    s_add_u32 m0, s91, 7168
    s_add_u32 s92, s90, 2100224
    buffer_load_dwordx4 v2, s[12:15], s92 offen sc1 lds
L_cnb:
    s_lshl_b32 s3, s38, 6
    v_add_u32 v208, s3, v0
    v_lshrrev_b32 v1, 3, v208
    s_lshl_b32 s3, s39, 6
    v_add_u32 v1, s3, v1
    v_lshlrev_b32 v1, 10, v1
    v_and_b32_e64 v2, 7, v208
    v_lshl_add_u32 v1, v2, 4, v1
    s_lshl_b32 s3, s40, 7
    v_add_u32 v209, s3, v1
    buffer_load_dwordx4 v[200:203], v209, s[4:7], 0 offen
    s_waitcnt vmcnt(0) lgkmcnt(0)
    v_mov_b32 v1, 157200
    v_mov_b32_e64 v2, 1
    s_mov_b64 exec, 1
    ds_add_u32 v1, v2
    s_mov_b64 exec, -1
    s_mov_b32 s58, 160000
L20_ts:
    ds_read_b32 v3, v1
    s_waitcnt lgkmcnt(0)
    v_readfirstlane_b32 s3, v3
    s_nop 1
    s_cmp_ge_u32 s3, 4
    s_cbranch_scc1 L21_tsd
    s_sleep 1
    s_sub_u32 s58, s58, 1
    s_cmp_lg_u32 s58, 0
    s_cbranch_scc1 L20_ts
L21_tsd:
    s_setprio 1
    s_branch L_bz
L_att_stub1:
    ds_read_b128 v[20:23], v12 offset:8192
    s_mov_b64 exec, s[46:47]
    ds_read_b128 v[32:35], v14 offset:8192
    ds_read_b128 v[36:39], v14 offset:8704
    s_mov_b64 exec, -1
    s_waitcnt lgkmcnt(2)
    v_mfma_f32_32x32x16_bf16 v[64:79], v[20:23], v[4:7], 0
    ds_read_b128 v[16:19], v12 offset:16384
    s_nop 7
    s_branch L_att_step1
L_att_stub2:
    ds_read_b128 v[16:19], v12 offset:16384
    s_mov_b64 exec, s[46:47]
    ds_read_b128 v[24:27], v14 offset:16384
    ds_read_b128 v[28:31], v14 offset:16896
    s_mov_b64 exec, -1
    s_waitcnt lgkmcnt(2)
    v_mfma_f32_32x32x16_bf16 v[48:63], v[16:19], v[4:7], 0
    ds_read_b128 v[20:23], v12 offset:24576
    s_cmp_eq_u32 s93, 0
    s_cbranch_scc1 L22_nwo
    s_add_u32 m0, s55, 0
    s_mov_b32 s56, 0
    buffer_load_dwordx4 v128, s[16:19], s56 offen lds
L22_nwo:
    s_nop 7
    s_branch L_att_step2
L_att_stub3:
    ds_read_b128 v[20:23], v12 offset:24576
    s_mov_b64 exec, s[46:47]
    ds_read_b128 v[32:35], v14 offset:24576
    ds_read_b128 v[36:39], v14 offset:25088
    s_mov_b64 exec, -1
    s_waitcnt lgkmcnt(2)
    v_mfma_f32_32x32x16_bf16 v[64:79], v[20:23], v[4:7], 0
    ds_read_b128 v[16:19], v13 offset:0
    s_cmp_eq_u32 s93, 0
    s_cbranch_scc1 L23_nwo
    s_add_u32 m0, s55, 0
    s_mov_b32 s56, 0
    s_nop 0
    buffer_load_dwordx4 v128, s[16:19], s56 offen lds
    s_add_u32 m0, s55, 1024
    s_mov_b32 s56, 8192
    buffer_load_dwordx4 v128, s[16:19], s56 offen lds
L23_nwo:
    s_nop 7
    s_branch L_att_step3
L_att_stub4:
    ds_read_b128 v[16:19], v13 offset:0
    s_mov_b64 exec, s[46:47]
    ds_read_b128 v[24:27], v15 offset:0
    ds_read_b128 v[28:31], v15 offset:512
    s_mov_b64 exec, -1
    s_waitcnt lgkmcnt(2)
    v_mfma_f32_32x32x16_bf16 v[48:63], v[16:19], v[4:7], 0
    ds_read_b128 v[20:23], v13 offset:8192
    s_cmp_eq_u32 s93, 0
    s_cbranch_scc1 L24_nwo
    s_add_u32 m0, s55, 0
    s_mov_b32 s56, 0
    s_nop 0
    buffer_load_dwordx4 v128, s[16:19], s56 offen lds
    s_add_u32 m0, s55, 1024
    s_mov_b32 s56, 8192
    buffer_load_dwordx4 v128, s[16:19], s56 offen lds
    s_add_u32 m0, s55, 2048
    s_mov_b32 s56, 16384
    buffer_load_dwordx4 v128, s[16:19], s56 offen lds
L24_nwo:
    s_nop 7
    s_branch L_att_step4
L_att_stub5:
    ds_read_b128 v[20:23], v13 offset:8192
    s_mov_b64 exec, s[46:47]
    ds_read_b128 v[32:35], v15 offset:8192
    ds_read_b128 v[36:39], v15 offset:8704
    s_mov_b64 exec, -1
    s_waitcnt lgkmcnt(2)
    v_mfma_f32_32x32x16_bf16 v[64:79], v[20:23], v[4:7], 0
    ds_read_b128 v[16:19], v13 offset:16384
    s_cmp_eq_u32 s93, 0
    s_cbranch_scc1 L25_nwo
    s_add_u32 m0, s55, 0
    s_mov_b32 s56, 0
    s_nop 0
    buffer_load_dwordx4 v128, s[16:19], s56 offen lds
    s_add_u32 m0, s55, 1024
    s_mov_b32 s56, 8192
    buffer_load_dwordx4 v128, s[16:19], s56 offen lds
    s_add_u32 m0, s55, 2048
    s_mov_b32 s56, 16384
    buffer_load_dwordx4 v128, s[16:19], s56 offen lds
    s_add_u32 m0, s55, 3072
    s_mov_b32 s56, 24576
    buffer_load_dwordx4 v128, s[16:19], s56 offen lds
L25_nwo:
    s_nop 7
    s_branch L_att_step5
L_att_stub6:
    ds_read_b128 v[16:19], v13 offset:16384
    s_mov_b64 exec, s[46:47]
    ds_read_b128 v[24:27], v15 offset:16384
    ds_read_b128 v[28:31], v15 offset:16896
    s_mov_b64 exec, -1
    s_waitcnt lgkmcnt(2)
    v_mfma_f32_32x32x16_bf16 v[48:63], v[16:19], v[4:7], 0
    ds_read_b128 v[20:23], v13 offset:24576
    s_cmp_eq_u32 s93, 0
    s_cbranch_scc1 L26_nwo
    s_add_u32 m0, s55, 0
    s_mov_b32 s56, 0
    s_nop 0
    buffer_load_dwordx4 v128, s[16:19], s56 offen lds
    s_add_u32 m0, s55, 1024
    s_mov_b32 s56, 8192
    buffer_load_dwordx4 v128, s[16:19], s56 offen lds
    s_add_u32 m0, s55, 2048
    s_mov_b32 s56, 16384
    buffer_load_dwordx4 v128, s[16:19], s56 offen lds
    s_add_u32 m0, s55, 3072
    s_mov_b32 s56, 24576
    buffer_load_dwordx4 v128, s[16:19], s56 offen lds
    s_add_u32 m0, s55, 4096
    s_mov_b32 s56, 32768
    buffer_load_dwordx4 v128, s[16:19], s56 offen lds
L26_nwo:
    s_nop 7
    s_branch L_att_step6
L_att_stub7:
    ds_read_b128 v[20:23], v13 offset:24576
    s_mov_b64 exec, s[46:47]
    ds_read_b128 v[32:35], v15 offset:24576
    ds_read_b128 v[36:39], v15 offset:25088
    s_mov_b64 exec, -1
    s_waitcnt lgkmcnt(2)
    v_mfma_f32_32x32x16_bf16 v[64:79], v[20:23], v[4:7], 0
    ds_read_b128 v[16:19], v13 offset:32768
    s_cmp_eq_u32 s93, 0
    s_cbranch_scc1 L27_nwo
    s_add_u32 m0, s55, 0
    s_mov_b32 s56, 0
    s_nop 0
    buffer_load_dwordx4 v128, s[16:19], s56 offen lds
    s_add_u32 m0, s55, 1024
    s_mov_b32 s56, 8192
    buffer_load_dwordx4 v128, s[16:19], s56 offen lds
    s_add_u32 m0, s55, 2048
    s_mov_b32 s56, 16384
    buffer_load_dwordx4 v128, s[16:19], s56 offen lds
    s_add_u32 m0, s55, 3072
    s_mov_b32 s56, 24576
    buffer_load_dwordx4 v128, s[16:19], s56 offen lds
    s_add_u32 m0, s55, 4096
    s_mov_b32 s56, 32768
    buffer_load_dwordx4 v128, s[16:19], s56 offen lds
    s_add_u32 m0, s55, 5120
    s_mov_b32 s56, 40960
    buffer_load_dwordx4 v128, s[16:19], s56 offen lds
L27_nwo:
    s_nop 7
    s_branch L_att_step7
L_att_stub8:
    ds_read_b128 v[16:19], v13 offset:32768
    s_mov_b64 exec, s[46:47]
    ds_read_b128 v[24:27], v15 offset:32768
    ds_read_b128 v[28:31], v15 offset:33280
    s_mov_b64 exec, -1
    s_waitcnt lgkmcnt(2)
    v_mfma_f32_32x32x16_bf16 v[48:63], v[16:19], v[4:7], v[96:111]
    s_cmp_eq_u32 s93, 0
    s_cbranch_scc1 L28_nwo
    s_add_u32 m0, s55, 0
    s_mov_b32 s56, 0
    s_nop 0
    buffer_load_dwordx4 v128, s[16:19], s56 offen lds
    s_add_u32 m0, s55, 1024
    s_mov_b32 s56, 8192
    buffer_load_dwordx4 v128, s[16:19], s56 offen lds
    s_add_u32 m0, s55, 2048
    s_mov_b32 s56, 16384
    buffer_load_dwordx4 v128, s[16:19], s56 offen lds
    s_add_u32 m0, s55, 3072
    s_mov_b32 s56, 24576
    buffer_load_dwordx4 v128, s[16:19], s56 offen lds
    s_add_u32 m0, s55, 4096
    s_mov_b32 s56, 32768
    buffer_load_dwordx4 v128, s[16:19], s56 offen lds
    s_add_u32 m0, s55, 5120
    s_mov_b32 s56, 40960
    buffer_load_dwordx4 v128, s[16:19], s56 offen lds
    s_add_u32 m0, s55, 6144
    s_mov_b32 s56, 49152
    buffer_load_dwordx4 v128, s[16:19], s56 offen lds
L28_nwo:
    s_nop 7
    s_branch L_att_step8
L_att_slow:
    s_sub_i32 s52, 8, s45
    s_max_i32 s52, s52, 0
    v_mov_b32 v2, 0xf149f2ca
    s_mov_b32 s50, s52
L_att_p1:
    s_lshl_b32 s51, s50, 13
    v_add_u32_e64 v1, s51, v12
    ds_read_b128 v[16:19], v1
    s_waitcnt lgkmcnt(0)
    s_cmp_eq_u32 s50, 0
    s_cbranch_scc1 L_att_a_e
    s_cmp_eq_u32 s50, 8
    s_cbranch_scc1 L_att_a_d
    v_mfma_f32_32x32x16_bf16 v[48:63], v[16:19], v[4:7], 0
    s_branch L_att_a_j
L_att_a_e:
    v_mfma_f32_32x32x16_bf16 v[48:63], v[16:19], v[4:7], v[112:127]
    s_branch L_att_a_j
L_att_a_d:
    v_mfma_f32_32x32x16_bf16 v[48:63], v[16:19], v[4:7], v[96:111]
L_att_a_j:
    s_nop 11
    v_max_f32 v2, v2, v48
    v_max_f32 v2, v2, v49
    v_max_f32 v2, v2, v50
    v_max_f32 v2, v2, v51
    v_max_f32 v2, v2, v52
    v_max_f32 v2, v2, v53
    v_max_f32 v2, v2, v54
    v_max_f32 v2, v2, v55
    v_max_f32 v2, v2, v56
    v_max_f32 v2, v2, v57
    v_max_f32 v2, v2, v58
    v_max_f32 v2, v2, v59
    v_max_f32 v2, v2, v60
    v_max_f32 v2, v2, v61
    v_max_f32 v2, v2, v62
    v_max_f32 v2, v2, v63
    s_add_u32 s50, s50, 1
    s_cmp_le_u32 s50, 8
    s_cbranch_scc1 L_att_p1
    v_mov_b32 v1, v2
    s_nop 1
    v_permlane32_swap_b32 v2, v1
    v_max_f32 v2, v2, v1
    v_mov_b32 v80, 0
    v_mov_b32 v81, 0
    v_mov_b32 v82, 0
    v_mov_b32 v83, 0
    v_mov_b32 v84, 0
    v_mov_b32 v85, 0
    v_mov_b32 v86, 0
    v_mov_b32 v87, 0
    v_mov_b32 v88, 0
    v_mov_b32 v89, 0
    v_mov_b32 v90, 0
    v_mov_b32 v91, 0
    v_mov_b32 v92, 0
    v_mov_b32 v93, 0
    v_mov_b32 v94, 0
    v_mov_b32 v95, 0
    s_mov_b32 s50, s52
L_att_p2:
    s_lshl_b32 s51, s50, 13
    v_add_u32 v1, s51, v12
    ds_read_b128 v[16:19], v1
    s_waitcnt lgkmcnt(0)
    s_cmp_eq_u32 s50, 0
    s_cbranch_scc1 L_att_b_e
    s_cmp_eq_u32 s50, 8
    s_cbranch_scc1 L_att_b_d
    v_mfma_f32_32x32x16_bf16 v[48:63], v[16:19], v[4:7], 0
    s_branch L_att_b_j
L_att_b_e:
    v_mfma_f32_32x32x16_bf16 v[48:63], v[16:19], v[4:7], v[112:127]
    s_branch L_att_b_j
L_att_b_d:
    v_mfma_f32_32x32x16_bf16 v[48:63], v[16:19], v[4:7], v[96:111]
L_att_b_j:
    v_add_u32_e64 v1, s51, v14
    s_mov_b64 exec, s[46:47]
    ds_read_b128 v[24:27], v1
    ds_read_b128 v[28:31], v1 offset:512
    s_mov_b64 exec, -1
    s_nop 6
    v_sub_f32 v48, v48, v2
    v_exp_f32 v48, v48
    v_sub_f32 v49, v49, v2
    v_exp_f32 v49, v49
    v_sub_f32 v50, v50, v2
    v_exp_f32 v50, v50
    v_sub_f32 v51, v51, v2
    v_exp_f32 v51, v51
    v_sub_f32 v52, v52, v2
    v_exp_f32 v52, v52
    v_sub_f32 v53, v53, v2
    v_exp_f32 v53, v53
    v_sub_f32 v54, v54, v2
    v_exp_f32 v54, v54
    v_sub_f32 v55, v55, v2
    v_exp_f32 v55, v55
    v_sub_f32 v56, v56, v2
    v_exp_f32 v56, v56
    v_sub_f32 v57, v57, v2
    v_exp_f32 v57, v57
    v_sub_f32 v58, v58, v2
    v_exp_f32 v58, v58
    v_sub_f32 v59, v59, v2
    v_exp_f32 v59, v59
    v_sub_f32 v60, v60, v2
    v_exp_f32 v60, v60
    v_sub_f32 v61, v61, v2
    v_exp_f32 v61, v61
    v_sub_f32 v62, v62, v2
    v_exp_f32 v62, v62
    v_sub_f32 v63, v63, v2
    v_exp_f32 v63, v63
    v_cvt_pk_bf16_f32 v40, v48, v49
    v_cvt_pk_bf16_f32 v41, v50, v51
    v_cvt_pk_bf16_f32 v42, v52, v53
    v_cvt_pk_bf16_f32 v43, v54, v55
    v_cvt_pk_bf16_f32 v44, v56, v57
    v_cvt_pk_bf16_f32 v45, v58, v59
    v_cvt_pk_bf16_f32 v46, v60, v61
    v_cvt_pk_bf16_f32 v47, v62, v63
    s_waitcnt lgkmcnt(0)
    v_mfma_f32_32x32x16_bf16 v[80:95], v[24:27], v[40:43], v[80:95]
    v_mfma_f32_32x32x16_bf16 v[80:95], v[28:31], v[44:47], v[80:95]
    s_add_u32 s50, s50, 1
    s_cmp_le_u32 s50, 8
    s_cbranch_scc1 L_att_p2
    s_branch L_att_fin
L_fnext:
    s_cmp_eq_u32 s69, 3
    s_cbranch_scc1 L_fc_p3
    s_mov_b32 s69, 3
    s_add_u32 s68, s68, 4
    s_xor_b32 s68, s68, 0
    s_branch L_setup2
L_fc_p3:
    s_setprio 0
    s_mov_b32 s86, 81920
    s_mov_b32 s87, 65536
    v_lshlrev_b32 v22, 4, v208
    v_add_u32 v23, s87, v22
    v_mov_b32 v1, 157204
    v_mov_b32_e64 v2, 1
    s_waitcnt vmcnt(0) lgkmcnt(0)
    s_mov_b64 exec, 1
    ds_add_rtn_u32 v3, v1, v2
    s_waitcnt lgkmcnt(0)
    v_readfirstlane_b32 s3, v3
    s_mov_b64 exec, -1
    s_nop 0
    s_cmp_lg_u32 s3, 3
    s_cbranch_scc1 L_fc_nf
    s_lshl_b32 s3, s39, 3
    s_add_u32 s3, s3, s40
    s_lshl_b32 s3, s3, 7
    s_add_u32 s3, s3, 0xa18000
    v_mov_b32 v2, s3
    v_mov_b32 v3, s41
    s_mov_b64 exec, 1
    buffer_store_dword v3, v2, s[12:15], 0 offen sc1
    s_mov_b64 exec, -1
L_fc_nf:
    s_cmp_lg_u32 s93, 0
    s_cbranch_scc1 L_havewo2
    v_lshrrev_b32 v3, 3, v0
    s_lshl_b32 s3, s38, 7
    v_add_u32 v3, s3, v3
    v_lshlrev_b32 v3, 10, v3
    s_lshl_b32 s3, s40, 7
    v_add_u32_e64 v3, s3, v3
    v_bfe_u32 v1, v0, 4, 1
    v_lshlrev_b32 v1, 2, v1
    v_and_b32 v2, 7, v0
    v_xor_b32_e64 v1, v1, v2
    v_lshl_add_u32 v9, v1, 4, v3
    s_lshl_b32 s44, s38, 14
    s_add_u32 m0, s44, 0
    s_mov_b32 s46, 0
    s_nop 0
    buffer_load_dwordx4 v9, s[16:19], s46 offen lds
    s_add_u32 m0, s44, 1024
    s_mov_b32 s46, 8192
    buffer_load_dwordx4 v9, s[16:19], s46 offen lds
    s_add_u32 m0, s44, 2048
    s_mov_b32 s46, 16384
    buffer_load_dwordx4 v9, s[16:19], s46 offen lds
    s_add_u32 m0, s44, 3072
    s_mov_b32 s46, 24576
    buffer_load_dwordx4 v9, s[16:19], s46 offen lds
    s_add_u32 m0, s44, 4096
    s_mov_b32 s46, 32768
    buffer_load_dwordx4 v9, s[16:19], s46 offen lds
    s_add_u32 m0, s44, 5120
    s_mov_b32 s46, 40960
    buffer_load_dwordx4 v9, s[16:19], s46 offen lds
    s_add_u32 m0, s44, 6144
    s_mov_b32 s46, 49152
    buffer_load_dwordx4 v9, s[16:19], s46 offen lds
    s_add_u32 m0, s44, 7168
    s_mov_b32 s46, 57344
    buffer_load_dwordx4 v9, s[16:19], s46 offen lds
    s_add_u32 m0, s44, 8192
    s_mov_b32 s46, 65536
    buffer_load_dwordx4 v9, s[16:19], s46 offen lds
    s_add_u32 m0, s44, 9216
    s_mov_b32 s46, 73728
    buffer_load_dwordx4 v9, s[16:19], s46 offen lds
    s_add_u32 m0, s44, 10240
    s_mov_b32 s46, 81920
    buffer_load_dwordx4 v9, s[16:19], s46 offen lds
    s_add_u32 m0, s44, 11264
    s_mov_b32 s46, 90112
    buffer_load_dwordx4 v9, s[16:19], s46 offen lds
    s_add_u32 m0, s44, 12288
    s_mov_b32 s46, 98304
    buffer_load_dwordx4 v9, s[16:19], s46 offen lds
    s_add_u32 m0, s44, 13312
    s_mov_b32 s46, 106496
    buffer_load_dwordx4 v9, s[16:19], s46 offen lds
    s_add_u32 m0, s44, 14336
    s_mov_b32 s46, 114688
    buffer_load_dwordx4 v9, s[16:19], s46 offen lds
    s_add_u32 m0, s44, 15360
    s_mov_b32 s46, 122880
    buffer_load_dwordx4 v9, s[16:19], s46 offen lds
L_havewo2:
    v_mov_b32 v1, 157204
    s_mov_b32 s58, 160000
L37_ts:
    ds_read_b32 v3, v1
    s_waitcnt lgkmcnt(0)
    v_readfirstlane_b32 s3, v3
    s_nop 1
    s_cmp_ge_u32 s3, 4
    s_cbranch_scc1 L38_tsd
    s_sleep 1
    s_sub_u32 s58, s58, 1
    s_cmp_lg_u32 s58, 0
    s_cbranch_scc1 L37_ts
L38_tsd:
    s_lshl_b32 s44, s38, 1
    s_lshl_b32 s3, s39, 3
    s_add_u32 s3, s3, s44
    s_lshl_b32 s3, s3, 7
    s_add_u32 s3, s3, 0xa18000
    v_lshl_add_u32 v2, v0, 7, s3
    s_mov_b64 exec, 3
    s_mov_b32 s58, 20000
L39_poll:
    buffer_load_dword v3, v2, s[12:15], 0 offen sc1
    s_waitcnt vmcnt(0)
    v_cmp_ne_u32 vcc, s41, v3
    s_nop 1
    s_cbranch_vccz L40_polld
    s_sub_u32 s58, s58, 1
    s_cmp_lg_u32 s58, 0
    s_cbranch_scc1 L39_poll
L40_polld:
    s_mov_b64 exec, -1
    s_lshl_b32 s46, s39, 6
    s_lshl_b32 s47, s38, 3
    s_add_u32 s46, s46, s47
    s_lshl_b32 s46, s46, 10
    s_add_u32 s46, s46, 0x800000
    s_lshl_b32 s44, s38, 13
    s_add_u32 s44, s44, s86
    v_lshlrev_b32_e64 v4, 4, v0
    s_add_u32 m0, s44, 0
    s_add_u32 s47, s46, 0
    buffer_load_dwordx4 v4, s[12:15], s47 offen sc1 lds
    s_add_u32 m0, s44, 1024
    s_add_u32 s47, s46, 1024
    buffer_load_dwordx4 v4, s[12:15], s47 offen sc1 lds
    s_add_u32 m0, s44, 2048
    s_add_u32 s47, s46, 2048
    buffer_load_dwordx4 v4, s[12:15], s47 offen sc1 lds
    s_add_u32 m0, s44, 3072
    s_add_u32 s47, s46, 3072
    buffer_load_dwordx4 v4, s[12:15], s47 offen sc1 lds
    s_add_u32 m0, s44, 4096
    s_add_u32 s47, s46, 4096
    buffer_load_dwordx4 v4, s[12:15], s47 offen sc1 lds
    s_add_u32 m0, s44, 5120
    s_add_u32 s47, s46, 5120
    buffer_load_dwordx4 v4, s[12:15], s47 offen sc1 lds
    s_add_u32 m0, s44, 6144
    s_add_u32 s47, s46, 6144
    buffer_load_dwordx4 v4, s[12:15], s47 offen sc1 lds
    s_add_u32 m0, s44, 7168
    s_add_u32 s47, s46, 7168
    buffer_load_dwordx4 v4, s[12:15], s47 offen sc1 lds
    s_add_u32 m0, s44, 32768
    s_add_u32 s47, s46, 32768
    buffer_load_dwordx4 v4, s[12:15], s47 offen sc1 lds
    s_add_u32 m0, s44, 33792
    s_add_u32 s47, s46, 33792
    buffer_load_dwordx4 v4, s[12:15], s47 offen sc1 lds
    s_add_u32 m0, s44, 34816
    s_add_u32 s47, s46, 34816
    buffer_load_dwordx4 v4, s[12:15], s47 offen sc1 lds
    s_add_u32 m0, s44, 35840
    s_add_u32 s47, s46, 35840
    buffer_load_dwordx4 v4, s[12:15], s47 offen sc1 lds
    s_add_u32 m0, s44, 36864
    s_add_u32 s47, s46, 36864
    buffer_load_dwordx4 v4, s[12:15], s47 offen sc1 lds
    s_add_u32 m0, s44, 37888
    s_add_u32 s47, s46, 37888
    buffer_load_dwordx4 v4, s[12:15], s47 offen sc1 lds
    s_add_u32 m0, s44, 38912
    s_add_u32 s47, s46, 38912
    buffer_load_dwordx4 v4, s[12:15], s47 offen sc1 lds
    s_add_u32 m0, s44, 39936
    s_add_u32 s47, s46, 39936
    buffer_load_dwordx4 v4, s[12:15], s47 offen sc1 lds
    s_cmp_eq_u32 s93, 0
    s_cbranch_scc1 L_lfr
    s_lshr_b32 s44, s38, 1
    v_lshrrev_b32 v1, 5, v0
    v_lshlrev_b32_e64 v1, 2, v1
    v_bfe_u32 v2, v0, 2, 2
    v_add_u32 v1, v1, v2
    v_lshlrev_b32 v5, 7, v1
    v_bfe_u32 v1, v0, 4, 1
    v_lshlrev_b32_e64 v1, 1, v1
    v_bfe_u32 v2, v0, 1, 1
    v_add_u32 v1, v1, v2
    s_lshl_b32 s3, s44, 2
    v_add_u32_e64 v1, s3, v1
    v_bfe_u32 v2, v0, 3, 1
    v_lshlrev_b32 v2, 2, v2
    v_xor_b32 v1, v1, v2
    v_lshl_add_u32 v5, v1, 4, v5
    v_and_b32_e64 v1, 1, v0
    v_lshl_add_u32 v5, v1, 3, v5
    ds_read_b64_tr_b16 v[72:73], v5 offset:0
    ds_read_b64_tr_b16 v[74:75], v5 offset:1024
    ds_read_b64_tr_b16 v[76:77], v5 offset:2048
    ds_read_b64_tr_b16 v[78:79], v5 offset:3072
    ds_read_b64_tr_b16 v[80:81], v5 offset:4096
    ds_read_b64_tr_b16 v[82:83], v5 offset:5120
    ds_read_b64_tr_b16 v[84:85], v5 offset:6144
    ds_read_b64_tr_b16 v[86:87], v5 offset:7168
    ds_read_b64_tr_b16 v[88:89], v5 offset:8192
    ds_read_b64_tr_b16 v[90:91], v5 offset:9216
    ds_read_b64_tr_b16 v[92:93], v5 offset:10240
    ds_read_b64_tr_b16 v[94:95], v5 offset:11264
    ds_read_b64_tr_b16 v[96:97], v5 offset:12288
    ds_read_b64_tr_b16 v[98:99], v5 offset:13312
    ds_read_b64_tr_b16 v[100:101], v5 offset:14336
    ds_read_b64_tr_b16 v[102:103], v5 offset:15360
    ds_read_b64_tr_b16 v[104:105], v5 offset:16384
    ds_read_b64_tr_b16 v[106:107], v5 offset:17408
    ds_read_b64_tr_b16 v[108:109], v5 offset:18432
    ds_read_b64_tr_b16 v[110:111], v5 offset:19456
    ds_read_b64_tr_b16 v[112:113], v5 offset:20480
    ds_read_b64_tr_b16 v[114:115], v5 offset:21504
    ds_read_b64_tr_b16 v[116:117], v5 offset:22528
    ds_read_b64_tr_b16 v[118:119], v5 offset:23552
    ds_read_b64_tr_b16 v[120:121], v5 offset:24576
    ds_read_b64_tr_b16 v[122:123], v5 offset:25600
    ds_read_b64_tr_b16 v[124:125], v5 offset:26624
    ds_read_b64_tr_b16 v[126:127], v5 offset:27648
    ds_read_b64_tr_b16 v[128:129], v5 offset:28672
    ds_read_b64_tr_b16 v[130:131], v5 offset:29696
    ds_read_b64_tr_b16 v[132:133], v5 offset:30720
    ds_read_b64_tr_b16 v[134:135], v5 offset:31744
    ds_read_b64_tr_b16 v[136:137], v5 offset:32768
    ds_read_b64_tr_b16 v[138:139], v5 offset:33792
    ds_read_b64_tr_b16 v[140:141], v5 offset:34816
    ds_read_b64_tr_b16 v[142:143], v5 offset:35840
    ds_read_b64_tr_b16 v[144:145], v5 offset:36864
    ds_read_b64_tr_b16 v[146:147], v5 offset:37888
    ds_read_b64_tr_b16 v[148:149], v5 offset:38912
    ds_read_b64_tr_b16 v[150:151], v5 offset:39936
    ds_read_b64_tr_b16 v[152:153], v5 offset:40960
    ds_read_b64_tr_b16 v[154:155], v5 offset:41984
    ds_read_b64_tr_b16 v[156:157], v5 offset:43008
    ds_read_b64_tr_b16 v[158:159], v5 offset:44032
    ds_read_b64_tr_b16 v[160:161], v5 offset:45056
    ds_read_b64_tr_b16 v[162:163], v5 offset:46080
    ds_read_b64_tr_b16 v[164:165], v5 offset:47104
    ds_read_b64_tr_b16 v[166:167], v5 offset:48128
    ds_read_b64_tr_b16 v[168:169], v5 offset:49152
    ds_read_b64_tr_b16 v[170:171], v5 offset:50176
    ds_read_b64_tr_b16 v[172:173], v5 offset:51200
    ds_read_b64_tr_b16 v[174:175], v5 offset:52224
    ds_read_b64_tr_b16 v[176:177], v5 offset:53248
    ds_read_b64_tr_b16 v[178:179], v5 offset:54272
    ds_read_b64_tr_b16 v[180:181], v5 offset:55296
    ds_read_b64_tr_b16 v[182:183], v5 offset:56320
    ds_read_b64_tr_b16 v[184:185], v5 offset:57344
    ds_read_b64_tr_b16 v[186:187], v5 offset:58368
    ds_read_b64_tr_b16 v[188:189], v5 offset:59392
    ds_read_b64_tr_b16 v[190:191], v5 offset:60416
    ds_read_b64_tr_b16 v[192:193], v5 offset:61440
    ds_read_b64_tr_b16 v[194:195], v5 offset:62464
    ds_read_b64_tr_b16 v[196:197], v5 offset:63488
    ds_read_b64_tr_b16 v[198:199], v5 offset:64512
L_lfr:
    s_waitcnt vmcnt(0) lgkmcnt(0)
    v_mov_b32 v1, 157208
    v_mov_b32_e64 v2, 1
    s_mov_b64 exec, 1
    ds_add_u32 v1, v2
    s_mov_b64 exec, -1
    s_mov_b32 s58, 160000
L41_ts:
    ds_read_b32 v3, v1
    s_waitcnt lgkmcnt(0)
    v_readfirstlane_b32 s3, v3
    s_nop 1
    s_cmp_ge_u32 s3, 4
    s_cbranch_scc1 L42_tsd
    s_sleep 1
    s_sub_u32 s58, s58, 1
    s_cmp_lg_u32 s58, 0
    s_cbranch_scc1 L41_ts
L42_tsd:
    s_cmp_lg_u32 s93, 0
    s_cbranch_scc1 L_lfr2
    s_lshr_b32 s44, s38, 1
    v_lshrrev_b32 v1, 5, v0
    v_lshlrev_b32_e64 v1, 2, v1
    v_bfe_u32 v2, v0, 2, 2
    v_add_u32 v1, v1, v2
    v_lshlrev_b32 v5, 7, v1
    v_bfe_u32 v1, v0, 4, 1
    v_lshlrev_b32_e64 v1, 1, v1
    v_bfe_u32 v2, v0, 1, 1
    v_add_u32 v1, v1, v2
    s_lshl_b32 s3, s44, 2
    v_add_u32_e64 v1, s3, v1
    v_bfe_u32 v2, v0, 3, 1
    v_lshlrev_b32 v2, 2, v2
    v_xor_b32 v1, v1, v2
    v_lshl_add_u32 v5, v1, 4, v5
    v_and_b32_e64 v1, 1, v0
    v_lshl_add_u32 v5, v1, 3, v5
    ds_read_b64_tr_b16 v[72:73], v5 offset:0
    ds_read_b64_tr_b16 v[74:75], v5 offset:1024
    ds_read_b64_tr_b16 v[76:77], v5 offset:2048
    ds_read_b64_tr_b16 v[78:79], v5 offset:3072
    ds_read_b64_tr_b16 v[80:81], v5 offset:4096
    ds_read_b64_tr_b16 v[82:83], v5 offset:5120
    ds_read_b64_tr_b16 v[84:85], v5 offset:6144
    ds_read_b64_tr_b16 v[86:87], v5 offset:7168
    ds_read_b64_tr_b16 v[88:89], v5 offset:8192
    ds_read_b64_tr_b16 v[90:91], v5 offset:9216
    ds_read_b64_tr_b16 v[92:93], v5 offset:10240
    ds_read_b64_tr_b16 v[94:95], v5 offset:11264
    ds_read_b64_tr_b16 v[96:97], v5 offset:12288
    ds_read_b64_tr_b16 v[98:99], v5 offset:13312
    ds_read_b64_tr_b16 v[100:101], v5 offset:14336
    ds_read_b64_tr_b16 v[102:103], v5 offset:15360
    ds_read_b64_tr_b16 v[104:105], v5 offset:16384
    ds_read_b64_tr_b16 v[106:107], v5 offset:17408
    ds_read_b64_tr_b16 v[108:109], v5 offset:18432
    ds_read_b64_tr_b16 v[110:111], v5 offset:19456
    ds_read_b64_tr_b16 v[112:113], v5 offset:20480
    ds_read_b64_tr_b16 v[114:115], v5 offset:21504
    ds_read_b64_tr_b16 v[116:117], v5 offset:22528
    ds_read_b64_tr_b16 v[118:119], v5 offset:23552
    ds_read_b64_tr_b16 v[120:121], v5 offset:24576
    ds_read_b64_tr_b16 v[122:123], v5 offset:25600
    ds_read_b64_tr_b16 v[124:125], v5 offset:26624
    ds_read_b64_tr_b16 v[126:127], v5 offset:27648
    ds_read_b64_tr_b16 v[128:129], v5 offset:28672
    ds_read_b64_tr_b16 v[130:131], v5 offset:29696
    ds_read_b64_tr_b16 v[132:133], v5 offset:30720
    ds_read_b64_tr_b16 v[134:135], v5 offset:31744
    ds_read_b64_tr_b16 v[136:137], v5 offset:32768
    ds_read_b64_tr_b16 v[138:139], v5 offset:33792
    ds_read_b64_tr_b16 v[140:141], v5 offset:34816
    ds_read_b64_tr_b16 v[142:143], v5 offset:35840
    ds_read_b64_tr_b16 v[144:145], v5 offset:36864
    ds_read_b64_tr_b16 v[146:147], v5 offset:37888
    ds_read_b64_tr_b16 v[148:149], v5 offset:38912
    ds_read_b64_tr_b16 v[150:151], v5 offset:39936
    ds_read_b64_tr_b16 v[152:153], v5 offset:40960
    ds_read_b64_tr_b16 v[154:155], v5 offset:41984
    ds_read_b64_tr_b16 v[156:157], v5 offset:43008
    ds_read_b64_tr_b16 v[158:159], v5 offset:44032
    ds_read_b64_tr_b16 v[160:161], v5 offset:45056
    ds_read_b64_tr_b16 v[162:163], v5 offset:46080
    ds_read_b64_tr_b16 v[164:165], v5 offset:47104
    ds_read_b64_tr_b16 v[166:167], v5 offset:48128
    ds_read_b64_tr_b16 v[168:169], v5 offset:49152
    ds_read_b64_tr_b16 v[170:171], v5 offset:50176
    ds_read_b64_tr_b16 v[172:173], v5 offset:51200
    ds_read_b64_tr_b16 v[174:175], v5 offset:52224
    ds_read_b64_tr_b16 v[176:177], v5 offset:53248
    ds_read_b64_tr_b16 v[178:179], v5 offset:54272
    ds_read_b64_tr_b16 v[180:181], v5 offset:55296
    ds_read_b64_tr_b16 v[182:183], v5 offset:56320
    ds_read_b64_tr_b16 v[184:185], v5 offset:57344
    ds_read_b64_tr_b16 v[186:187], v5 offset:58368
    ds_read_b64_tr_b16 v[188:189], v5 offset:59392
    ds_read_b64_tr_b16 v[190:191], v5 offset:60416
    ds_read_b64_tr_b16 v[192:193], v5 offset:61440
    ds_read_b64_tr_b16 v[194:195], v5 offset:62464
    ds_read_b64_tr_b16 v[196:197], v5 offset:63488
    ds_read_b64_tr_b16 v[198:199], v5 offset:64512
    s_waitcnt lgkmcnt(0)
L_lfr2:
    s_branch L_gemm
L_fl_p3:
    s_setprio 0
    s_mov_b32 s87, 65536
    v_mov_b32 v36, 0
    v_mov_b32 v37, 0
    v_mov_b32 v38, 0
    v_mov_b32 v39, 0
    v_lshlrev_b32 v22, 4, v208
    v_add_u32_e64 v23, s87, v22
    ds_write_b128 v23, v[36:39]
    v_subrev_u32 v22, 0x1000, v23
    ds_write_b128 v22, v[36:39]
    s_waitcnt lgkmcnt(0)
    v_mov_b32 v1, 157212
    v_mov_b32_e64 v2, 1
    s_mov_b64 exec, 1
    ds_add_u32 v1, v2
    s_mov_b64 exec, -1
    s_mov_b32 s58, 160000
L43_ts:
    ds_read_b32 v3, v1
    s_waitcnt lgkmcnt(0)
    v_readfirstlane_b32 s3, v3
    s_nop 1
    s_cmp_ge_u32 s3, 4
    s_cbranch_scc1 L44_tsd
    s_sleep 1
    s_sub_u32 s58, s58, 1
    s_cmp_lg_u32 s58, 0
    s_cbranch_scc1 L43_ts
L44_tsd:
    s_branch L_yred
L_codeend:
    s_endpgm
.section .rodata,"a"
.p2align 6
.amdhsa_kernel parallel_sum__sliding_block__moe_arch_mod__prompt_kernel
  .amdhsa_next_free_vgpr 256
  .amdhsa_next_free_sgpr 102
  .amdhsa_accum_offset 256
  .amdhsa_float_denorm_mode_32 3
  .amdhsa_group_segment_fixed_size 0
  .amdhsa_kernarg_size 88
  .amdhsa_user_sgpr_count 2
  .amdhsa_user_sgpr_kernarg_segment_ptr 1
  .amdhsa_system_sgpr_workgroup_id_x 1
.end_amdhsa_kernel
```
